```python
import torch

def _softmax(x, axis=-1):
    return torch.softmax(x, dim=axis)
def _gelu(x):
    return torch.nn.functional.gelu(x, approximate="tanh")
def _silu(x):
    return torch.nn.functional.silu(x)
def _sigmoid(x):
    return torch.sigmoid(x)
def _layernorm(x, axis=-1, eps=1e-5):
    m = x.mean(dim=axis, keepdim=True)
    v = x.var(dim=axis, keepdim=True, unbiased=False)
    return (x - m) / torch.sqrt(v + eps)
def _scatter_add(tgt, idx, src, axis=0):
    return tgt.clone().index_add_(axis, idx, src)
def _segment_sum(src, seg, n):
    out = torch.zeros((n,) + src.shape[1:], dtype=src.dtype)
    return out.index_add_(0, seg, src)
def _pad(x, pw):
    flat = tuple(v for pair in reversed(pw) for v in pair)
    return torch.nn.functional.pad(x, flat)

kernel_name = 'parallel_sum__sliding_block__mixer_channel_mlp__prompt'

def setup_inputs():

    _w = (lambda a: (lambda t: t.to(torch.bfloat16) if t.is_floating_point() else t)(torch.as_tensor(a)))
    def _A_setup():
        B, S, D = 1, 2048, 512
        return {
            "x": _w((lambda *s: torch.randn(*s, dtype=torch.bfloat16) * 0.05)(B, S, D)),
            "wqkv": _w((lambda *s: torch.randn(*s, dtype=torch.bfloat16) * 0.05)(D, 3 * D)),
            "wo": _w((lambda *s: torch.randn(*s, dtype=torch.bfloat16) * 0.05)(D, D)),
        }
    _A_in = _A_setup()

    def _B_setup():
        B, S, D, F = 1, 2048, 512, 1376
        return {
            "x": _w((lambda *s: torch.randn(*s, dtype=torch.bfloat16) * 0.05)(B, S, D)),
            "w1": _w((lambda *s: torch.randn(*s, dtype=torch.bfloat16) * 3.2)(D, F) * (D ** -0.5)),
            "b1": _w((lambda *s: torch.randn(*s, dtype=torch.bfloat16) * 1.6)(F)),
            "w2": _w((lambda *s: torch.randn(*s, dtype=torch.bfloat16) * 0.2)(F, D) * (F ** -0.5)),
            "b2": _w((lambda *s: torch.randn(*s, dtype=torch.bfloat16) * 0.2)(D)),
        }
    _B_in = _B_setup()

    return {
        "A_x": _A_in["x"],
        "A_wqkv": _A_in["wqkv"],
        "A_wo": _A_in["wo"],
        "B_x": _B_in["x"],
        "B_w1": _B_in["w1"],
        "B_b1": _B_in["b1"],
        "B_w2": _B_in["w2"],
        "B_b2": _B_in["b2"],
    }

def reference(A_x, A_wqkv, A_wo, B_x, B_w1, B_b1, B_w2, B_b2):
    def _A_ref(x, wqkv, wo):
        B, S, D = x.shape
        H = 32; Dh = D // H; W = 256
        qkv = (lambda x, *d: x.permute(*d))((x @ wqkv).reshape(B, S, 3, H, Dh), 2, 0, 3, 1, 4)
        q, k, v = qkv[0], qkv[1], qkv[2]
        scores = torch.einsum("bhqd,bhkd->bhqk", q, k) * (Dh ** -0.5)
        idx = torch.arange(S)
        mask = (idx[:, None] - idx[None, :] >= 0) & (idx[:, None] - idx[None, :] < W)
        scores = torch.where(mask[None, None], scores, -1e9)
        p = _softmax(scores, axis=-1)
        o = torch.einsum("bhqk,bhkd->bhqd", p, v)
        return (lambda x, *d: x.permute(*d))(o, 0, 2, 1, 3).reshape(B, S, D) @ wo

    def _B_ref(x, w1, b1, w2, b2):
        y = _layernorm(x, axis=-1)
        h = _gelu(torch.einsum("bsd,df->bsf", y, w1) + b1)
        return torch.einsum("bsf,fd->bsd", h, w2) + b2

    x = A_x
    xn = _layernorm(x, axis=-1)
    return x + _A_ref(xn, A_wqkv, A_wo) + _B_ref(xn, B_w1, B_b1, B_w2, B_b2)
```

```asm
; @launch grid=(256,1,1) block=(512,1,1) lds=163840
.amdgcn_target "amdgcn-amd-amdhsa--gfx950"
.text
.globl parallel_sum__sliding_block__mixer_channel_mlp__prompt_kernel
.p2align 8
.type parallel_sum__sliding_block__mixer_channel_mlp__prompt_kernel,@function
parallel_sum__sliding_block__mixer_channel_mlp__prompt_kernel:
s_load_dwordx16 s[4:19], s[0:1], 0
s_load_dwordx4 s[20:23], s[0:1], 64
s_load_dwordx2 s[24:25], s[0:1], 80
s_cmp_ge_u32 s2, 256
s_cbranch_scc1 L_end
v_lshrrev_b32 v1, 6, v0
v_and_b32 v0, 63, v0
v_readfirstlane_b32 s64, v1
s_and_b32 s82, s2, 7
s_lshr_b32 s83, s2, 3
s_getpc_b64 s[56:57]
L_pc:
s_and_b32 s57, s57, 0xffff
s_mov_b32 s58, L_codeend-L_pc
s_mov_b32 s59, 0x20000
s_and_b32 s86, s83, 7
s_lshl_b32 s86, s86, 3
s_add_u32 s86, s86, s64
s_lshl_b32 s86, s86, 9
v_lshlrev_b32 v100, 7, v0
s_mov_b64 exec, 15
buffer_load_dword v100, v100, s[56:59], s86 offen
s_mov_b64 exec, -1
s_and_b32 s65, s82, 1
s_lshl_b32 s65, s65, 3
s_and_b32 s86, s83, 7
s_add_u32 s65, s65, s86
s_lshr_b32 s66, s82, 1
s_lshl_b32 s66, s66, 2
s_lshr_b32 s87, s83, 3
s_add_u32 s66, s66, s87
s_lshl_b32 s77, s87, 1
s_add_u32 s77, s77, s86
s_and_b32 s77, s77, 7
s_lshl_b32 s77, s77, 7
v_lshrrev_b32 v72, 3, v0
v_lshrrev_b32 v73, 4, v0
v_and_b32 v74, 7, v0
v_xor_b32 v75, v74, v73
v_lshlrev_b32 v75, 4, v75
v_lshl_add_u32 v12, v72, 10, v75
s_lshl_b32 s86, s65, 17
s_lshl_b32 s87, s64, 14
s_add_u32 s86, s86, s87
v_add_u32 v12, s86, v12
v_xor_b32 v13, 64, v12
v_add_u32 v13, 7168, v13
v_and_b32 v73, 1, v73
v_lshlrev_b32 v73, 2, v73
v_xor_b32 v75, v74, v73
v_lshlrev_b32 v75, 4, v75
s_and_b32 s86, s66, 1
s_lshl_b32 s86, s86, 10
s_lshr_b32 s87, s66, 1
s_lshl_b32 s87, s87, 7
s_add_u32 s86, s86, s87
s_mul_i32 s87, s64, 24576
s_add_u32 s86, s86, s87
s_add_u32 s86, s86, 1024
v_mul_u32_u24 v14, 3072, v72
v_add3_u32 v14, v14, v75, s86
s_lshl_b32 s79, s64, 11
s_lshl_b32 s80, s64, 10
v_lshlrev_b32 v1, 4, v0
s_lshl_b32 s76, s65, 4
s_add_u32 s76, s76, s66
s_lshl_b32 s76, s76, 13
s_add_u32 s76, s76, s80
s_waitcnt lgkmcnt(0)
s_mov_b32 s28, s4
s_and_b32 s29, s5, 0xffff
s_mov_b32 s30, 2097152
s_mov_b32 s31, 0x20000
s_mov_b32 s32, s6
s_and_b32 s33, s7, 0xffff
s_mov_b32 s34, 1572864
s_mov_b32 s35, 0x20000
buffer_load_dwordx4 v[124:127], v1, s[28:31], s76 offen
s_add_u32 m0, s79, 0
s_mul_i32 s89, s77, 1536
buffer_load_dwordx4 v12, s[28:31], s77 offen lds
buffer_load_dwordx4 v13, s[28:31], s77 offen offset:1024 lds
s_add_u32 m0, s80, 65536
s_add_u32 s77, s77, 128
s_and_b32 s77, s77, 1023
buffer_load_dwordx4 v14, s[32:35], s89 offen lds
s_mov_b32 s60, s22
s_and_b32 s61, s23, 0xffff
s_mov_b32 s62, 256
s_mov_b32 s63, 0x20000
s_or_b32 s86, s2, s64
s_cmp_eq_u32 s86, 0
s_cbranch_scc1 L_nonce
L_nonce_ret:
s_lshl_b32 s71, s82, 2
s_and_b32 s86, s83, 3
s_add_u32 s71, s71, s86
s_lshr_b32 s72, s83, 2
s_lshl_b32 s93, s86, 1
s_add_u32 s93, s93, s72
s_and_b32 s67, s64, 3
s_lshr_b32 s68, s64, 2
s_lshl_b32 s69, s68, 1
s_xor_b32 s69, s69, s67
s_and_b32 s74, s64, 1
s_lshr_b32 s73, s64, 1
s_lshl_b32 s75, s65, 2
s_add_u32 s75, s75, s67
s_mov_b32 s44, s24
s_and_b32 s45, s25, 0xffff
s_mov_b32 s46, 14680064
s_mov_b32 s47, 0x20000
v_lshl_add_u32 v2, v72, 10, v75
v_and_b32 v73, 31, v0
v_lshrrev_b32 v74, 5, v0
v_bfe_u32 v75, v0, 1, 3
v_xor_b32 v75, v75, v74
v_lshlrev_b32 v75, 4, v75
s_lshl_b32 s82, s67, 12
s_lshl_b32 s83, s69, 5
v_lshl_add_u32 v75, v73, 7, v75
v_add_u32 v75, s82, v75
v_xor_b32 v20, s83, v75
v_xor_b32 v21, 32, v20
v_xor_b32 v22, 64, v20
v_xor_b32 v23, 96, v20
v_bfe_u32 v112, v0, 2, 2
v_and_b32 v113, 3, v0
v_bfe_u32 v114, v0, 4, 1
v_lshrrev_b32 v115, 1, v113
v_lshl_add_u32 v115, v114, 1, v115
v_bfe_u32 v116, v0, 3, 1
v_lshlrev_b32 v116, 2, v116
v_xor_b32 v115, v115, v116
v_lshlrev_b32 v115, 4, v115
v_and_b32 v116, 1, v113
v_lshl_add_u32 v115, v116, 3, v115
v_lshl_add_u32 v117, v74, 3, v112
s_lshl_b32 s82, s68, 6
s_lshl_b32 s83, s69, 11
s_add_u32 s83, s83, 65536
v_xor_b32 v80, s82, v115
v_lshl_add_u32 v80, v117, 7, v80
v_add_u32 v24, s83, v80
v_xor_b32 v25, 2048, v24
v_xor_b32 v26, 4096, v24
v_xor_b32 v27, 6144, v24
v_and_b32 v75, 3, v0
v_lshrrev_b32 v76, 2, v0
v_lshrrev_b32 v77, 4, v0
v_xor_b32 v76, v76, v77
v_and_b32 v76, 1, v76
v_or_b32 v75, v75, v76
v_cmp_eq_u32 vcc, 0, v75
v_mov_b32 v44, 0x3f803f80
s_nop 0
v_cndmask_b32 v52, 0, v44, vcc
v_cndmask_b32 v53, 0, v44, vcc
v_cndmask_b32 v54, 0, v44, vcc
v_cndmask_b32 v55, 0, v44, vcc
s_mov_b32 s36, s16
s_and_b32 s37, s17, 0xffff
s_mov_b32 s38, 1409024
s_mov_b32 s39, 0x20000
s_mov_b32 s40, s8
s_and_b32 s41, s9, 0xffff
s_mov_b32 s42, 524288
s_mov_b32 s43, 0x20000
s_mov_b32 s48, s20
s_and_b32 s49, s21, 0xffff
s_mov_b32 s50, 2097152
s_mov_b32 s51, 0x20000
s_mov_b32 s56, s14
s_and_b32 s57, s15, 0xffff
s_mov_b32 s58, 2752
s_mov_b32 s59, 0x20000
s_mov_b32 s26, s18
s_mov_b32 s27, s19
s_mul_i32 s82, s66, 3
s_lshl_b32 s83, s66, 1
s_add_u32 s83, s83, 11
s_min_u32 s70, s82, s83
s_mov_b32 s82, 1409024
s_movk_i32 s83, 1376
s_cmp_ge_u32 s64, 6
s_cselect_b32 s52, s6, s12
s_cselect_b32 s53, s7, s13
s_cselect_b32 s54, 1572864, s82
s_cselect_b32 s78, 1536, s83
s_cselect_b32 s87, s66, s70
s_cselect_b64 s[10:11], -1, 0
s_and_b32 s53, s53, 0xffff
s_mov_b32 s55, 0x20000
s_lshl_b32 s87, s87, 6
s_lshl_b32 s82, s64, 7
v_add_u32 v118, s82, v0
v_mul_u32_u24 v119, 5462, v118
v_lshrrev_b32 v119, 16, v119
v_mul_u32_u24 v120, 12, v119
v_sub_u32 v120, v118, v120
v_lshlrev_b32 v120, 4, v120
v_mul_u32_u24 v119, 2752, v119
v_add_u32 v15, v119, v120
v_add_u32 v118, s82, v0
v_add_u32 v118, 64, v118
v_mul_u32_u24 v119, 5462, v118
v_lshrrev_b32 v119, 16, v119
v_mul_u32_u24 v120, 12, v119
v_sub_u32 v120, v118, v120
v_lshlrev_b32 v120, 4, v120
v_mul_u32_u24 v119, 2752, v119
v_add_u32 v16, v119, v120
s_lshl_b32 s82, s74, 5
v_lshrrev_b32 v118, 2, v0
v_add_u32 v118, s82, v118
v_mul_u32_u24 v118, 3072, v118
v_and_b32 v119, 3, v0
v_lshl_add_u32 v118, v119, 4, v118
v_add_u32 v119, 49152, v118
v_cndmask_b32 v15, v15, v118, s[10:11]
v_cndmask_b32 v16, v16, v119, s[10:11]
v_add_u32 v15, s87, v15
s_sub_u32 s87, s87, 1024
v_add_u32 v16, s87, v16
v_lshlrev_b32 v115, 5, v114
v_lshl_add_u32 v115, v113, 3, v115
v_mul_u32_u24 v116, 192, v117
v_add_u32 v116, v116, v115
s_mov_b32 s82, 98432
s_cmp_eq_u32 s68, 0
s_cselect_b32 s86, 64, 192
s_cselect_b32 s87, 110592, s82
v_mul_u32_u24 v117, s86, v117
v_add_u32 v117, v117, v115
s_lshl_b32 s88, s68, 6
s_add_u32 s88, s88, 98304
v_add_u32 v116, s88, v116
v_add_u32 v117, s87, v117
s_lshl_b32 s88, s86, 2
s_xor_b32 s82, s69, 0
s_mul_i32 s83, s82, 3072
v_add_u32 v28, s83, v116
s_mul_i32 s83, s82, s86
s_lshl_b32 s83, s83, 4
v_add_u32 v32, s83, v117
v_add_u32 v36, s88, v32
s_xor_b32 s82, s69, 1
s_mul_i32 s83, s82, 3072
v_add_u32 v29, s83, v116
s_mul_i32 s83, s82, s86
s_lshl_b32 s83, s83, 4
v_add_u32 v33, s83, v117
v_add_u32 v37, s88, v33
s_xor_b32 s82, s69, 2
s_mul_i32 s83, s82, 3072
v_add_u32 v30, s83, v116
s_mul_i32 s83, s82, s86
s_lshl_b32 s83, s83, 4
v_add_u32 v34, s83, v117
v_add_u32 v38, s88, v34
s_xor_b32 s82, s69, 3
s_mul_i32 s83, s82, 3072
v_add_u32 v31, s83, v116
s_mul_i32 s83, s82, s86
s_lshl_b32 s83, s83, 4
v_add_u32 v35, s83, v117
v_add_u32 v39, s88, v35
v_mov_b32 v45, v44
v_mov_b32 v46, v44
v_mov_b32 v47, v44
v_add_u32 v112, 157696, v1
ds_write_b128 v112, v[44:47]
v_and_b32 v112, 31, v0
v_lshrrev_b32 v113, 5, v0
v_lshlrev_b32 v113, 2, v113
v_sub_u32 v112, v112, v113
s_lshl_b32 s82, s67, 3
v_subrev_u32 v112, s82, v112
s_cmp_eq_u32 s68, 0
s_cselect_b32 s82, 0, 0xf149f2ca
s_cselect_b32 s83, 0xf149f2ca, 0
v_mov_b32 v113, s82
v_mov_b32 v114, s83
v_cmp_le_i32 vcc, 0, v112
s_nop 1
v_cndmask_b32 v48, v114, v113, vcc
v_cmp_le_i32 vcc, 1, v112
s_nop 1
v_cndmask_b32 v49, v114, v113, vcc
v_cmp_le_i32 vcc, 2, v112
s_nop 1
v_cndmask_b32 v50, v114, v113, vcc
v_cmp_le_i32 vcc, 3, v112
s_nop 1
v_cndmask_b32 v51, v114, v113, vcc
s_add_u32 s82, s80, 147456
v_add_u32 v112, s82, v1
ds_write_b128 v112, v[48:51]
s_lshl_b32 s86, s74, 13
s_lshl_b32 s87, s72, 7
s_add_u32 s86, s86, s87
v_add_u32 v2, s86, v2
s_mul_i32 s91, s73, 22
s_add_u32 m0, s79, 16384
s_mul_i32 s89, s77, 1536
buffer_load_dwordx4 v12, s[28:31], s77 offen lds
buffer_load_dwordx4 v13, s[28:31], s77 offen offset:1024 lds
s_add_u32 m0, s80, 73728
s_add_u32 s77, s77, 128
s_and_b32 s77, s77, 1023
buffer_load_dwordx4 v14, s[32:35], s89 offen lds
buffer_load_dwordx2 v[4:5], off, s[60:63], 0 sc1
s_waitcnt vmcnt(7)
v_lshlrev_b32 v96, 16, v124
v_and_b32 v97, 0xffff0000, v124
v_lshlrev_b32 v98, 16, v125
v_and_b32 v99, 0xffff0000, v125
v_lshlrev_b32 v100, 16, v126
v_and_b32 v101, 0xffff0000, v126
v_lshlrev_b32 v102, 16, v127
v_and_b32 v103, 0xffff0000, v127
v_add_f32 v124, v96, v97
v_add_f32 v124, v124, v98
v_add_f32 v124, v124, v99
v_add_f32 v124, v124, v100
v_add_f32 v124, v124, v101
v_add_f32 v124, v124, v102
v_add_f32 v124, v124, v103
s_nop 1
v_add_f32_dpp v124, v124, v124 quad_perm:[1,0,3,2] row_mask:0xf bank_mask:0xf
s_nop 1
v_add_f32_dpp v124, v124, v124 quad_perm:[2,3,0,1] row_mask:0xf bank_mask:0xf
s_nop 1
v_add_f32_dpp v124, v124, v124 row_half_mirror row_mask:0xf bank_mask:0xf
s_nop 1
v_add_f32_dpp v124, v124, v124 row_mirror row_mask:0xf bank_mask:0xf
v_mov_b32 v126, v124
s_nop 1
v_permlane16_swap_b32 v124, v126
v_add_f32 v124, v124, v126
v_mov_b32 v126, v124
s_nop 1
v_permlane32_swap_b32 v124, v126
v_add_f32 v124, v124, v126
v_mul_f32 v124, 0x3b000000, v124
v_sub_f32 v96, v96, v124
v_sub_f32 v97, v97, v124
v_sub_f32 v98, v98, v124
v_sub_f32 v99, v99, v124
v_sub_f32 v100, v100, v124
v_sub_f32 v101, v101, v124
v_sub_f32 v102, v102, v124
v_sub_f32 v103, v103, v124
v_mul_f32 v125, v96, v96
v_fmac_f32 v125, v97, v97
v_fmac_f32 v125, v98, v98
v_fmac_f32 v125, v99, v99
v_fmac_f32 v125, v100, v100
v_fmac_f32 v125, v101, v101
v_fmac_f32 v125, v102, v102
v_fmac_f32 v125, v103, v103
s_nop 1
v_add_f32_dpp v125, v125, v125 quad_perm:[1,0,3,2] row_mask:0xf bank_mask:0xf
s_nop 1
v_add_f32_dpp v125, v125, v125 quad_perm:[2,3,0,1] row_mask:0xf bank_mask:0xf
s_nop 1
v_add_f32_dpp v125, v125, v125 row_half_mirror row_mask:0xf bank_mask:0xf
s_nop 1
v_add_f32_dpp v125, v125, v125 row_mirror row_mask:0xf bank_mask:0xf
v_mov_b32 v126, v125
s_nop 1
v_permlane16_swap_b32 v125, v126
v_add_f32 v125, v125, v126
v_mov_b32 v126, v125
s_nop 1
v_permlane32_swap_b32 v125, v126
v_add_f32 v125, v125, v126
v_mul_f32 v125, 0x3b000000, v125
s_lshr_b32 s3, s76, 6
s_add_u32 s3, s3, 12648448
s_add_u32 m0, s79, 32768
s_mul_i32 s89, s77, 1536
buffer_load_dwordx4 v12, s[28:31], s77 offen lds
buffer_load_dwordx4 v13, s[28:31], s77 offen offset:1024 lds
s_add_u32 m0, s80, 81920
s_add_u32 s77, s77, 128
s_and_b32 s77, s77, 1023
buffer_load_dwordx4 v14, s[32:35], s89 offen lds
s_waitcnt lgkmcnt(0)
s_waitcnt vmcnt(7)
s_barrier
ds_read_b128 v[128:131], v20 offset:0
ds_read_b64_tr_b16 v[72:73], v24 offset:0
ds_read_b64_tr_b16 v[74:75], v24 offset:512
ds_read_b128 v[132:135], v21 offset:0
ds_read_b64_tr_b16 v[76:77], v25 offset:0
ds_read_b64_tr_b16 v[78:79], v25 offset:512
ds_read_b128 v[136:139], v22 offset:0
ds_read_b64_tr_b16 v[80:81], v26 offset:0
ds_read_b64_tr_b16 v[82:83], v26 offset:512
ds_read_b128 v[140:143], v23 offset:0
ds_read_b64_tr_b16 v[84:85], v27 offset:0
ds_read_b64_tr_b16 v[86:87], v27 offset:512
s_waitcnt lgkmcnt(9)
v_mfma_f32_16x16x32_bf16 v[56:59], v[52:55], v[72:75], 0
v_mfma_f32_32x32x16_bf16 v[96:111], v[72:75], v[128:131], 0
s_waitcnt vmcnt(4)
s_barrier
ds_read_b128 v[144:147], v20 offset:16384
ds_read_b64_tr_b16 v[88:89], v24 offset:8192
ds_read_b64_tr_b16 v[90:91], v24 offset:8704
s_waitcnt lgkmcnt(9)
v_mfma_f32_32x32x16_bf16 v[96:111], v[76:79], v[132:135], v[96:111]
ds_read_b128 v[148:151], v21 offset:16384
ds_read_b64_tr_b16 v[92:93], v25 offset:8192
ds_read_b64_tr_b16 v[94:95], v25 offset:8704
s_add_u32 m0, s79, 49152
s_mul_i32 s89, s77, 1536
buffer_load_dwordx4 v12, s[28:31], s77 offen lds
buffer_load_dwordx4 v13, s[28:31], s77 offen offset:1024 lds
s_cmp_eq_u32 s73, 3
s_cselect_b32 s91, 65, s91
s_cmp_ge_u32 s73, 2
s_cselect_b32 s86, 21, 22
s_add_u32 s92, s91, s86
s_mul_i32 s90, s93, 11
s_lshr_b32 s90, s90, 2
s_waitcnt lgkmcnt(9)
v_mfma_f32_32x32x16_bf16 v[96:111], v[80:83], v[136:139], v[96:111]
ds_read_b128 v[152:155], v22 offset:16384
ds_read_b64_tr_b16 v[72:73], v26 offset:8192
ds_read_b64_tr_b16 v[74:75], v26 offset:8704
s_add_u32 m0, s80, 90112
s_add_u32 s77, s77, 128
s_and_b32 s77, s77, 1023
buffer_load_dwordx4 v14, s[32:35], s89 offen lds
v_and_b32 v6, 31, v0
s_lshl_b32 s76, s68, 9
s_lshl_b32 s5, s67, 2
s_add_u32 s76, s76, s5
s_add_u32 s76, s76, 158720
v_lshl_add_u32 v8, v6, 4, s76
v_subrev_u32 v71, s5, v8
s_lshl_b32 s76, s75, 9
s_add_u32 s76, s76, 12648448
v_lshl_add_u32 v70, v6, 4, s76
s_cmp_ge_u32 s90, s86
s_cselect_b32 s86, s86, 0
s_sub_u32 s90, s90, s86
s_add_u32 s90, s90, s91
s_lshl_b32 s86, s71, 1
s_add_u32 s86, s86, s74
s_waitcnt lgkmcnt(9)
v_mfma_f32_32x32x16_bf16 v[96:111], v[84:87], v[140:143], v[96:111]
ds_read_b128 v[156:159], v23 offset:16384
ds_read_b64_tr_b16 v[76:77], v27 offset:8192
ds_read_b64_tr_b16 v[78:79], v27 offset:8704
s_waitcnt vmcnt(6)
v_readfirstlane_b32 s85, v5
v_readfirstlane_b32 s84, v4
s_cmp_eq_u32 s85, 0
s_cbranch_scc1 L_nonspin
L_nonspin_ret:
v_mov_b32 v126, v4
v_mov_b32 v127, v5
s_mov_b64 exec, 1
buffer_store_dwordx4 v[124:127], off, s[44:47], s3 sc1
s_mov_b64 exec, -1
s_mul_i32 s87, s86, 86
s_add_u32 s87, s87, 6144
s_add_u32 s95, s90, s87
s_lshl_b32 s95, s95, 10
s_add_u32 s100, s91, s87
s_waitcnt lgkmcnt(9)
v_mfma_f32_16x16x32_bf16 v[56:59], v[52:55], v[88:91], v[56:59]
v_mfma_f32_32x32x16_bf16 v[96:111], v[88:91], v[144:147], v[96:111]
s_waitcnt vmcnt(4)
s_barrier
ds_read_b128 v[160:163], v20 offset:32768
ds_read_b64_tr_b16 v[80:81], v24 offset:16384
ds_read_b64_tr_b16 v[82:83], v24 offset:16896
s_waitcnt lgkmcnt(9)
v_mfma_f32_32x32x16_bf16 v[96:111], v[92:95], v[148:151], v[96:111]
ds_read_b128 v[164:167], v21 offset:32768
ds_read_b64_tr_b16 v[84:85], v25 offset:16384
ds_read_b64_tr_b16 v[86:87], v25 offset:16896
s_add_u32 m0, s79, 0
s_mul_i32 s89, s77, 1536
buffer_load_dwordx4 v12, s[28:31], s77 offen lds
s_lshl_b32 s100, s100, 10
s_add_u32 s101, s92, s87
s_lshl_b32 s101, s101, 10
s_lshl_b32 s90, s90, 14
s_lshl_b32 s91, s91, 14
s_waitcnt lgkmcnt(9)
v_mfma_f32_32x32x16_bf16 v[96:111], v[72:75], v[152:155], v[96:111]
ds_read_b128 v[168:171], v22 offset:32768
ds_read_b64_tr_b16 v[88:89], v26 offset:16384
ds_read_b64_tr_b16 v[90:91], v26 offset:16896
buffer_load_dwordx4 v13, s[28:31], s77 offen offset:1024 lds
s_lshl_b32 s92, s92, 14
s_and_b32 s93, s93, 7
s_lshl_b32 s16, s93, 10
s_lshl_b32 s93, s93, 14
s_lshl_b32 s17, s86, 5
s_waitcnt lgkmcnt(9)
v_mfma_f32_32x32x16_bf16 v[96:111], v[76:79], v[156:159], v[96:111]
ds_read_b128 v[172:175], v23 offset:32768
ds_read_b64_tr_b16 v[92:93], v27 offset:16384
ds_read_b64_tr_b16 v[94:95], v27 offset:16896
s_add_u32 m0, s80, 65536
s_add_u32 s77, s77, 128
s_and_b32 s77, s77, 1023
buffer_load_dwordx4 v14, s[32:35], s89 offen lds
s_lshl_b32 s87, s73, 3
s_add_u32 s17, s17, s87
s_lshl_b32 s17, s17, 10
s_add_u32 s17, s17, 4194304
s_mul_i32 s94, s73, 12288
s_waitcnt lgkmcnt(9)
v_mfma_f32_16x16x32_bf16 v[56:59], v[52:55], v[80:83], v[56:59]
v_mfma_f32_32x32x16_bf16 v[96:111], v[80:83], v[160:163], v[96:111]
s_waitcnt vmcnt(4)
s_barrier
ds_read_b128 v[176:179], v20 offset:49152
ds_read_b64_tr_b16 v[72:73], v24 offset:24576
ds_read_b64_tr_b16 v[74:75], v24 offset:25088
s_waitcnt lgkmcnt(9)
v_mfma_f32_32x32x16_bf16 v[96:111], v[84:87], v[164:167], v[96:111]
ds_read_b128 v[180:183], v21 offset:49152
ds_read_b64_tr_b16 v[76:77], v25 offset:24576
ds_read_b64_tr_b16 v[78:79], v25 offset:25088
s_add_u32 m0, s79, 16384
s_mul_i32 s89, s77, 1536
buffer_load_dwordx4 v12, s[28:31], s77 offen lds
s_lshl_b32 s87, s74, 10
s_add_u32 s94, s94, s87
s_lshl_b32 s81, s65, 4
s_add_u32 s81, s81, s66
s_lshl_b32 s81, s81, 8
s_waitcnt lgkmcnt(9)
v_mfma_f32_32x32x16_bf16 v[96:111], v[88:91], v[168:171], v[96:111]
ds_read_b128 v[184:187], v22 offset:49152
ds_read_b64_tr_b16 v[80:81], v26 offset:24576
ds_read_b64_tr_b16 v[82:83], v26 offset:25088
buffer_load_dwordx4 v13, s[28:31], s77 offen offset:1024 lds
s_lshl_b32 s87, s64, 3
s_add_u32 s81, s81, s87
s_add_u32 s81, s81, 12582912
s_lshl_b32 s86, s68, 21
s_lshl_b32 s82, s66, 17
s_waitcnt lgkmcnt(9)
v_mfma_f32_32x32x16_bf16 v[96:111], v[92:95], v[172:175], v[96:111]
ds_read_b128 v[188:191], v23 offset:49152
ds_read_b64_tr_b16 v[84:85], v27 offset:24576
ds_read_b64_tr_b16 v[86:87], v27 offset:25088
s_add_u32 m0, s80, 73728
s_add_u32 s77, s77, 128
s_and_b32 s77, s77, 1023
buffer_load_dwordx4 v14, s[32:35], s89 offen lds
s_add_u32 s86, s86, s82
s_lshl_b32 s82, s67, 10
s_add_u32 s86, s86, s82
s_mul_i32 s15, s68, 24576
s_add_u32 s15, s15, s82
s_waitcnt lgkmcnt(9)
v_mfma_f32_16x16x32_bf16 v[56:59], v[52:55], v[72:75], v[56:59]
v_mfma_f32_32x32x16_bf16 v[96:111], v[72:75], v[176:179], v[96:111]
s_waitcnt vmcnt(3)
s_barrier
ds_read_b128 v[192:195], v20 offset:0
ds_read_b64_tr_b16 v[88:89], v24 offset:0
ds_read_b64_tr_b16 v[90:91], v24 offset:512
s_waitcnt lgkmcnt(9)
v_mfma_f32_32x32x16_bf16 v[96:111], v[76:79], v[180:183], v[96:111]
ds_read_b128 v[196:199], v21 offset:0
ds_read_b64_tr_b16 v[92:93], v25 offset:0
ds_read_b64_tr_b16 v[94:95], v25 offset:512
s_add_u32 m0, s79, 32768
s_mul_i32 s89, s77, 1536
buffer_load_dwordx4 v12, s[28:31], s77 offen lds
s_sub_u32 s12, s65, 2
s_cselect_b32 s12, s65, s12
s_lshl_b32 s12, s12, 12
s_add_u32 s12, s12, s86
s_sub_u32 s13, s65, 1
s_cselect_b32 s13, s65, s13
s_lshl_b32 s13, s13, 12
s_waitcnt lgkmcnt(9)
v_mfma_f32_32x32x16_bf16 v[96:111], v[80:83], v[184:187], v[96:111]
ds_read_b128 v[200:203], v22 offset:0
ds_read_b64_tr_b16 v[72:73], v26 offset:0
ds_read_b64_tr_b16 v[74:75], v26 offset:512
buffer_load_dwordx4 v13, s[28:31], s77 offen offset:1024 lds
s_add_u32 s13, s13, s86
s_lshl_b32 s14, s65, 12
s_add_u32 s14, s14, s86
s_mul_i32 s86, s75, 86
s_add_u32 s82, s70, s68
s_waitcnt lgkmcnt(9)
v_mfma_f32_32x32x16_bf16 v[96:111], v[84:87], v[188:191], v[96:111]
ds_read_b128 v[204:207], v23 offset:0
ds_read_b64_tr_b16 v[76:77], v27 offset:0
ds_read_b64_tr_b16 v[78:79], v27 offset:512
s_add_u32 m0, s80, 81920
s_add_u32 s77, s77, 128
s_and_b32 s77, s77, 1023
buffer_load_dwordx4 v14, s[32:35], s89 offen lds
s_lshl_b32 s82, s82, 1
s_add_u32 s82, s82, s86
s_lshl_b32 s82, s82, 10
s_add_u32 s20, s82, 6291456
s_lshl_b32 s86, s75, 5
s_waitcnt lgkmcnt(9)
v_mfma_f32_16x16x32_bf16 v[56:59], v[52:55], v[88:91], v[56:59]
v_mfma_f32_32x32x16_bf16 v[96:111], v[88:91], v[192:195], v[96:111]
s_waitcnt vmcnt(3)
s_barrier
ds_read_b128 v[208:211], v20 offset:16384
ds_read_b64_tr_b16 v[80:81], v24 offset:8192
ds_read_b64_tr_b16 v[82:83], v24 offset:8704
buffer_load_dwordx4 v[64:67], v70, s[44:47], 0 offen sc1
s_waitcnt lgkmcnt(9)
v_mfma_f32_32x32x16_bf16 v[96:111], v[92:95], v[196:199], v[96:111]
ds_read_b128 v[212:215], v21 offset:16384
ds_read_b64_tr_b16 v[84:85], v25 offset:8192
ds_read_b64_tr_b16 v[86:87], v25 offset:8704
s_add_u32 m0, s79, 49152
s_mul_i32 s89, s77, 1536
buffer_load_dwordx4 v12, s[28:31], s77 offen lds
s_lshl_b32 s82, s66, 1
s_add_u32 s86, s86, s82
s_add_u32 s86, s86, s68
s_lshl_b32 s86, s86, 10
s_add_u32 s19, s86, 4194304
s_waitcnt lgkmcnt(9)
v_mfma_f32_32x32x16_bf16 v[96:111], v[72:75], v[200:203], v[96:111]
ds_read_b128 v[216:219], v22 offset:16384
ds_read_b64_tr_b16 v[88:89], v26 offset:8192
ds_read_b64_tr_b16 v[90:91], v26 offset:8704
buffer_load_dwordx4 v13, s[28:31], s77 offen offset:1024 lds
s_lshl_b32 s18, s71, 16
s_lshl_b32 s82, s64, 13
s_add_u32 s18, s18, s82
s_lshl_b32 s82, s72, 7
s_add_u32 s18, s18, s82
s_waitcnt lgkmcnt(9)
v_mfma_f32_32x32x16_bf16 v[96:111], v[76:79], v[204:207], v[96:111]
ds_read_b128 v[220:223], v23 offset:16384
ds_read_b64_tr_b16 v[92:93], v27 offset:8192
ds_read_b64_tr_b16 v[94:95], v27 offset:8704
s_add_u32 m0, s80, 90112
s_add_u32 s77, s77, 128
s_and_b32 s77, s77, 1023
buffer_load_dwordx4 v14, s[32:35], s89 offen lds
s_lshl_b32 s4, s73, 13
s_lshl_b32 s21, s74, 12
s_add_u32 s21, s21, s4
s_waitcnt lgkmcnt(9)
v_mfma_f32_16x16x32_bf16 v[56:59], v[52:55], v[80:83], v[56:59]
v_mfma_f32_32x32x16_bf16 v[96:111], v[80:83], v[208:211], v[96:111]
s_waitcnt vmcnt(4)
s_barrier
ds_read_b128 v[224:227], v20 offset:32768
ds_read_b64_tr_b16 v[72:73], v24 offset:16384
ds_read_b64_tr_b16 v[74:75], v24 offset:16896
s_waitcnt lgkmcnt(9)
v_mfma_f32_32x32x16_bf16 v[96:111], v[84:87], v[212:215], v[96:111]
ds_read_b128 v[228:231], v21 offset:32768
ds_read_b64_tr_b16 v[76:77], v25 offset:16384
ds_read_b64_tr_b16 v[78:79], v25 offset:16896
s_add_u32 m0, s79, 98304
s_mul_i32 s89, s77, s78
buffer_load_dwordx4 v15, s[52:55], s89 offen lds
s_waitcnt lgkmcnt(9)
v_mfma_f32_32x32x16_bf16 v[96:111], v[88:91], v[216:219], v[96:111]
ds_read_b128 v[232:235], v22 offset:32768
ds_read_b64_tr_b16 v[80:81], v26 offset:16384
ds_read_b64_tr_b16 v[82:83], v26 offset:16896
buffer_load_dwordx4 v16, s[52:55], s89 offen offset:1024 lds
s_add_u32 s77, s77, 128
s_and_b32 s77, s77, 1023
s_waitcnt lgkmcnt(9)
v_mfma_f32_32x32x16_bf16 v[96:111], v[92:95], v[220:223], v[96:111]
ds_read_b128 v[236:239], v23 offset:32768
ds_read_b64_tr_b16 v[84:85], v27 offset:16384
ds_read_b64_tr_b16 v[86:87], v27 offset:16896
v_and_b32 v18, 31, v0
v_lshlrev_b32 v18, 1, v18
s_add_u32 s76, s70, s68
s_lshl_b32 s76, s76, 6
buffer_load_ushort v17, v18, s[56:59], s76 offen
s_add_u32 s76, s70, 2
s_lshl_b32 s76, s76, 6
s_cmp_eq_u32 s68, 0
s_cselect_b32 s76, 0x10000, s76
buffer_load_ushort v18, v18, s[56:59], s76 offen
s_waitcnt lgkmcnt(9)
v_mfma_f32_16x16x32_bf16 v[56:59], v[52:55], v[72:75], v[56:59]
v_mfma_f32_32x32x16_bf16 v[96:111], v[72:75], v[224:227], v[96:111]
s_waitcnt vmcnt(4)
s_barrier
ds_read_b128 v[240:243], v20 offset:49152
ds_read_b64_tr_b16 v[88:89], v24 offset:24576
ds_read_b64_tr_b16 v[90:91], v24 offset:25088
s_waitcnt vmcnt(7)
v_cmp_ne_u64 vcc, s[84:85], v[66:67]
s_cbranch_vccnz Lgs_1
Lgs_1r:
s_waitcnt lgkmcnt(9)
v_mfma_f32_32x32x16_bf16 v[96:111], v[76:79], v[228:231], v[96:111]
ds_read_b128 v[244:247], v21 offset:49152
ds_read_b64_tr_b16 v[92:93], v25 offset:24576
ds_read_b64_tr_b16 v[94:95], v25 offset:25088
s_add_u32 m0, s79, 114688
s_mul_i32 s89, s77, s78
buffer_load_dwordx4 v15, s[52:55], s89 offen lds
v_add_f32 v68, 0x3727c5ac, v65
v_sub_f32 v64, 0, v64
v_rsq_f32 v19, v68
v_cvt_pk_bf16_f32 v40, v64, v64
v_mul_f32 v68, v65, v19
v_mov_b32 v69, 0x3727c5ac
v_and_b32 v40, 0xffff0000, v40
v_fma_f32 v68, v68, v19, v69
s_waitcnt lgkmcnt(9)
v_mfma_f32_32x32x16_bf16 v[96:111], v[80:83], v[232:235], v[96:111]
ds_read_b128 v[248:251], v22 offset:49152
ds_read_b64_tr_b16 v[72:73], v26 offset:24576
ds_read_b64_tr_b16 v[74:75], v26 offset:25088
buffer_load_dwordx4 v16, s[52:55], s89 offen offset:1024 lds
s_add_u32 s77, s77, 128
s_and_b32 s77, s77, 1023
v_sub_f32 v40, v64, v40
v_rsq_f32 v68, v68
v_cvt_pk_bf16_f32 v40, v64, v40
v_mul_f32 v68, v68, v19
v_rcp_f32 v11, v68
v_mul_f32 v9, 0xc0135761, v68
v_mul_f32 v10, v68, v68
v_mul_f32 v10, v10, v9
s_waitcnt lgkmcnt(9)
v_mfma_f32_32x32x16_bf16 v[96:111], v[84:87], v[236:239], v[96:111]
ds_read_b128 v[252:255], v23 offset:49152
ds_read_b64_tr_b16 v[76:77], v27 offset:24576
ds_read_b64_tr_b16 v[78:79], v27 offset:25088
v_mul_f32 v10, 0x3d372713, v10
v_cvt_pk_bf16_f32 v41, v64, v11
v_and_b32 v42, 0xffff0000, v41
v_sub_f32 v42, v11, v42
v_cvt_pk_bf16_f32 v42, v42, 0
v_mov_b32 v43, 0
s_mov_b32 exec_lo, 0
v_mov_b32 v40, 0
v_mov_b32 v41, 0
v_mov_b32 v42, 0
s_mov_b32 exec_lo, -1
v_and_b32 v6, 31, v0
s_waitcnt lgkmcnt(9)
v_mfma_f32_16x16x32_bf16 v[56:59], v[52:55], v[88:91], v[56:59]
v_mfma_f32_32x32x16_bf16 v[96:111], v[88:91], v[240:243], v[96:111]
v_lshrrev_b32 v7, 5, v0
v_lshlrev_b32 v6, 5, v6
v_lshl_add_u32 v6, v7, 4, v6
s_bitcmp1_b32 s66, 0
s_cselect_b64 s[10:11], -1, 0
s_cselect_b32 s82, 2097152, 0
s_lshr_b32 s83, s66, 1
s_lshl_b32 s83, s83, 1
s_add_u32 s83, s83, s68
s_lshl_b32 s83, s83, 17
s_waitcnt lgkmcnt(6)
v_mfma_f32_32x32x16_bf16 v[96:111], v[92:95], v[244:247], v[96:111]
v_cndmask_b32 v6, v1, v6, s[10:11]
s_add_u32 s82, s82, s83
s_lshl_b32 s83, s75, 10
s_add_u32 s82, s82, s83
s_add_u32 s83, s82, 65536
s_waitcnt lgkmcnt(0)
v_mfma_f32_32x32x16_bf16 v[96:111], v[72:75], v[248:251], v[96:111]
ds_write_b32 v8, v56
v_mfma_f32_32x32x16_bf16 v[96:111], v[76:79], v[252:255], v[96:111]
s_waitcnt lgkmcnt(0)
s_barrier
ds_read_b128 v[60:63], v71
s_waitcnt lgkmcnt(0)
v_add_f32 v60, v60, v61
v_add_f32 v62, v62, v63
v_add_f32 v60, v60, v62
v_cvt_pk_bf16_f32 v44, v60, v60
v_and_b32 v61, 0xffff0000, v44
v_sub_f32 v61, v60, v61
v_cvt_pk_bf16_f32 v45, v61, 0
v_mov_b32 v46, 0
v_mov_b32 v47, 0
s_nop 1
v_mfma_f32_32x32x16_bf16 v[96:111], v[44:47], v[40:43], v[96:111]
s_nop 11
v_pk_mul_f32 v[96:97], v[96:97], v[18:19] op_sel:[0,1] op_sel_hi:[1,1]
v_pk_mul_f32 v[98:99], v[98:99], v[18:19] op_sel:[0,1] op_sel_hi:[1,1]
v_pk_mul_f32 v[100:101], v[100:101], v[18:19] op_sel:[0,1] op_sel_hi:[1,1]
v_pk_mul_f32 v[102:103], v[102:103], v[18:19] op_sel:[0,1] op_sel_hi:[1,1]
v_cvt_pk_bf16_f32 v96, v96, v97
v_cvt_pk_bf16_f32 v97, v98, v99
v_cvt_pk_bf16_f32 v98, v100, v101
v_cvt_pk_bf16_f32 v99, v102, v103
buffer_store_dwordx4 v[96:99], v6, s[44:47], s82 offen sc1
v_pk_mul_f32 v[104:105], v[104:105], v[18:19] op_sel:[0,1] op_sel_hi:[1,1]
v_pk_mul_f32 v[106:107], v[106:107], v[18:19] op_sel:[0,1] op_sel_hi:[1,1]
v_pk_mul_f32 v[108:109], v[108:109], v[18:19] op_sel:[0,1] op_sel_hi:[1,1]
v_pk_mul_f32 v[110:111], v[110:111], v[18:19] op_sel:[0,1] op_sel_hi:[1,1]
v_cvt_pk_bf16_f32 v100, v104, v105
v_cvt_pk_bf16_f32 v101, v106, v107
v_cvt_pk_bf16_f32 v102, v108, v109
v_cvt_pk_bf16_f32 v103, v110, v111
buffer_store_dwordx4 v[100:103], v6, s[44:47], s83 offen sc1
s_waitcnt vmcnt(6)
s_barrier
ds_read_b64_tr_b16 v[72:73], v28 offset:0
ds_read_b64_tr_b16 v[74:75], v28 offset:768
ds_read_b64_tr_b16 v[76:77], v32 offset:0
ds_read_b64_tr_b16 v[78:79], v36 offset:0
ds_read_b64_tr_b16 v[80:81], v29 offset:0
ds_read_b64_tr_b16 v[82:83], v29 offset:768
ds_read_b64_tr_b16 v[84:85], v33 offset:0
ds_read_b64_tr_b16 v[86:87], v37 offset:0
s_waitcnt lgkmcnt(4)
v_mfma_f32_16x16x32_bf16 v[56:59], v[52:55], v[72:75], 0
v_mfma_f32_16x16x32_bf16 v[60:63], v[52:55], v[76:79], 0
v_mfma_f32_32x32x16_bf16 v[96:111], v[72:75], v[128:131], 0
v_mfma_f32_32x32x16_bf16 v[112:127], v[76:79], v[128:131], 0
ds_read_b64_tr_b16 v[88:89], v30 offset:0
ds_read_b64_tr_b16 v[90:91], v30 offset:768
ds_read_b64_tr_b16 v[92:93], v34 offset:0
ds_read_b64_tr_b16 v[94:95], v38 offset:0
s_add_u32 m0, s79, 131072
s_mul_i32 s89, s77, s78
buffer_load_dwordx4 v15, s[52:55], s89 offen lds
v_bfe_u32 v66, v0, 2, 2
v_and_b32 v67, 3, v0
v_bfe_u32 v68, v0, 4, 1
v_lshrrev_b32 v69, 1, v67
v_lshl_add_u32 v69, v68, 1, v69
s_waitcnt lgkmcnt(4)
v_mfma_f32_32x32x16_bf16 v[96:111], v[80:83], v[132:135], v[96:111]
v_mfma_f32_32x32x16_bf16 v[112:127], v[84:87], v[132:135], v[112:127]
ds_read_b64_tr_b16 v[72:73], v31 offset:0
ds_read_b64_tr_b16 v[74:75], v31 offset:768
ds_read_b64_tr_b16 v[76:77], v35 offset:0
ds_read_b64_tr_b16 v[78:79], v39 offset:0
buffer_load_dwordx4 v16, s[52:55], s89 offen offset:1024 lds
s_add_u32 s77, s77, 128
s_and_b32 s77, s77, 1023
v_bfe_u32 v70, v0, 3, 1
v_lshlrev_b32 v70, 2, v70
v_xor_b32 v69, v69, v70
v_lshlrev_b32 v69, 4, v69
v_and_b32 v70, 1, v67
s_waitcnt lgkmcnt(0)
v_mfma_f32_32x32x16_bf16 v[96:111], v[88:91], v[136:139], v[96:111]
v_mfma_f32_32x32x16_bf16 v[112:127], v[92:95], v[136:139], v[112:127]
s_waitcnt vmcnt(4)
s_barrier
ds_read_b64_tr_b16 v[80:81], v28 offset:16384
ds_read_b64_tr_b16 v[82:83], v28 offset:17152
ds_read_b64_tr_b16 v[84:85], v32 offset:16384
ds_read_b64_tr_b16 v[86:87], v36 offset:16384
v_mfma_f32_32x32x16_bf16 v[96:111], v[72:75], v[140:143], v[96:111]
v_mfma_f32_32x32x16_bf16 v[112:127], v[76:79], v[140:143], v[112:127]
ds_read_b64_tr_b16 v[88:89], v29 offset:16384
ds_read_b64_tr_b16 v[90:91], v29 offset:17152
ds_read_b64_tr_b16 v[92:93], v33 offset:16384
ds_read_b64_tr_b16 v[94:95], v37 offset:16384
s_add_u32 m0, s79, 98304
s_mul_i32 s89, s77, s78
buffer_load_dwordx4 v15, s[52:55], s89 offen lds
buffer_load_dwordx4 v16, s[52:55], s89 offen offset:1024 lds
s_add_u32 s77, s77, 128
s_and_b32 s77, s77, 1023
v_lshl_add_u32 v69, v70, 3, v69
v_lshrrev_b32 v70, 5, v0
s_lshl_b32 s83, s74, 6
v_xor_b32 v69, s83, v69
s_mul_i32 s83, s73, 12288
s_waitcnt lgkmcnt(4)
v_mfma_f32_16x16x32_bf16 v[56:59], v[52:55], v[80:83], v[56:59]
v_mfma_f32_16x16x32_bf16 v[60:63], v[52:55], v[84:87], v[60:63]
v_mfma_f32_32x32x16_bf16 v[96:111], v[80:83], v[144:147], v[96:111]
v_mfma_f32_32x32x16_bf16 v[112:127], v[84:87], v[144:147], v[112:127]
ds_read_b64_tr_b16 v[72:73], v30 offset:16384
ds_read_b64_tr_b16 v[74:75], v30 offset:17152
ds_read_b64_tr_b16 v[76:77], v34 offset:16384
ds_read_b64_tr_b16 v[78:79], v38 offset:16384
s_add_u32 m0, s94, 49152
s_nop 0
buffer_load_dwordx4 v2, s[36:39], s90 offen lds
v_add_u32 v69, s83, v69
v_lshl_add_u32 v23, v70, 2, v66
v_lshl_add_u32 v23, v23, 7, v69
v_lshl_add_u32 v24, v70, 9, v23
s_sub_u32 s82, s65, 2
s_cselect_b32 s82, s65, s82
s_waitcnt lgkmcnt(4)
v_mfma_f32_32x32x16_bf16 v[96:111], v[88:91], v[148:151], v[96:111]
v_mfma_f32_32x32x16_bf16 v[112:127], v[92:95], v[148:151], v[112:127]
ds_read_b64_tr_b16 v[80:81], v31 offset:16384
ds_read_b64_tr_b16 v[82:83], v31 offset:17152
ds_read_b64_tr_b16 v[84:85], v35 offset:16384
ds_read_b64_tr_b16 v[86:87], v39 offset:16384
s_add_u32 m0, s94, 51200
s_add_u32 s90, s90, 16384
s_cmp_eq_u32 s90, s92
s_cselect_b32 s90, s91, s90
buffer_load_dwordx4 v2, s[36:39], s90 offen lds
s_sub_u32 s83, s65, 1
s_cselect_b32 s83, s65, s83
v_mov_b32 v20, s65
v_writelane_b32 v20, s82, 0
v_writelane_b32 v20, s83, 1
s_and_b32 s82, s66, 14
s_waitcnt lgkmcnt(0)
v_mfma_f32_32x32x16_bf16 v[96:111], v[72:75], v[152:155], v[96:111]
v_mfma_f32_32x32x16_bf16 v[112:127], v[76:79], v[152:155], v[112:127]
s_waitcnt vmcnt(4)
s_barrier
ds_read_b64_tr_b16 v[88:89], v28 offset:32768
ds_read_b64_tr_b16 v[90:91], v28 offset:33536
ds_read_b64_tr_b16 v[92:93], v32 offset:32768
ds_read_b64_tr_b16 v[94:95], v36 offset:32768
v_mfma_f32_32x32x16_bf16 v[96:111], v[80:83], v[156:159], v[96:111]
v_mfma_f32_32x32x16_bf16 v[112:127], v[84:87], v[156:159], v[112:127]
ds_read_b64_tr_b16 v[72:73], v29 offset:32768
ds_read_b64_tr_b16 v[74:75], v29 offset:33536
ds_read_b64_tr_b16 v[76:77], v33 offset:32768
ds_read_b64_tr_b16 v[78:79], v37 offset:32768
s_waitcnt vmcnt(6)
s_mov_b64 exec, 1
buffer_store_dwordx2 v[4:5], off, s[44:47], s81 offset:0 sc1
s_mov_b64 exec, -1
s_add_u32 m0, s79, 114688
s_mul_i32 s89, s77, s78
buffer_load_dwordx4 v15, s[52:55], s89 offen lds
s_add_u32 s82, s82, s68
s_lshl_b32 s82, s82, 8
s_and_b32 s83, s66, 1
s_lshl_b32 s83, s83, 2
s_add_u32 s83, s83, s67
s_waitcnt lgkmcnt(4)
v_mfma_f32_16x16x32_bf16 v[56:59], v[52:55], v[88:91], v[56:59]
v_mfma_f32_16x16x32_bf16 v[60:63], v[52:55], v[92:95], v[60:63]
v_mfma_f32_32x32x16_bf16 v[96:111], v[88:91], v[160:163], v[96:111]
v_mfma_f32_32x32x16_bf16 v[112:127], v[92:95], v[160:163], v[112:127]
ds_read_b64_tr_b16 v[80:81], v30 offset:32768
ds_read_b64_tr_b16 v[82:83], v30 offset:33536
ds_read_b64_tr_b16 v[84:85], v34 offset:32768
ds_read_b64_tr_b16 v[86:87], v38 offset:32768
buffer_load_dwordx4 v16, s[52:55], s89 offen offset:1024 lds
s_add_u32 s77, s77, 128
s_and_b32 s77, s77, 1023
s_lshl_b32 s83, s83, 3
s_add_u32 s82, s82, s83
s_add_u32 s82, s82, 12582912
v_lshlrev_b32 v20, 12, v20
v_add_u32 v20, s82, v20
s_waitcnt lgkmcnt(4)
v_mfma_f32_32x32x16_bf16 v[96:111], v[72:75], v[164:167], v[96:111]
v_mfma_f32_32x32x16_bf16 v[112:127], v[76:79], v[164:167], v[112:127]
ds_read_b64_tr_b16 v[88:89], v31 offset:32768
ds_read_b64_tr_b16 v[90:91], v31 offset:33536
ds_read_b64_tr_b16 v[92:93], v35 offset:32768
ds_read_b64_tr_b16 v[94:95], v39 offset:32768
s_add_u32 m0, s94, 53248
s_add_u32 s90, s90, 16384
s_cmp_eq_u32 s90, s92
s_cselect_b32 s90, s91, s90
buffer_load_dwordx4 v2, s[36:39], s90 offen lds
v_add_u32 v12, 0x10000, v1
s_mul_i32 s82, s68, 12288
s_lshl_b32 s83, s67, 10
s_add_u32 s82, s82, s83
v_add_u32 v25, s82, v1
s_waitcnt lgkmcnt(0)
v_mfma_f32_32x32x16_bf16 v[96:111], v[80:83], v[168:171], v[96:111]
v_mfma_f32_32x32x16_bf16 v[112:127], v[84:87], v[168:171], v[112:127]
s_waitcnt vmcnt(6)
s_barrier
ds_read_b64_tr_b16 v[72:73], v28 offset:0
ds_read_b64_tr_b16 v[74:75], v28 offset:768
ds_read_b64_tr_b16 v[76:77], v32 offset:0
ds_read_b64_tr_b16 v[78:79], v36 offset:0
v_mfma_f32_32x32x16_bf16 v[96:111], v[88:91], v[172:175], v[96:111]
v_mfma_f32_32x32x16_bf16 v[112:127], v[92:95], v[172:175], v[112:127]
ds_read_b64_tr_b16 v[80:81], v29 offset:0
ds_read_b64_tr_b16 v[82:83], v29 offset:768
ds_read_b64_tr_b16 v[84:85], v33 offset:0
ds_read_b64_tr_b16 v[86:87], v37 offset:0
s_add_u32 m0, s79, 131072
s_mul_i32 s89, s77, s78
buffer_load_dwordx4 v15, s[52:55], s89 offen lds
v_lshlrev_b32 v69, 7, v70
v_lshl_add_u32 v69, v66, 5, v69
v_lshl_add_u32 v69, v67, 3, v69
s_add_u32 s82, s82, 32768
v_add_u32 v69, s82, v69
s_waitcnt lgkmcnt(4)
v_mfma_f32_16x16x32_bf16 v[56:59], v[52:55], v[72:75], v[56:59]
v_mfma_f32_16x16x32_bf16 v[60:63], v[52:55], v[76:79], v[60:63]
v_mfma_f32_32x32x16_bf16 v[96:111], v[72:75], v[176:179], v[96:111]
v_mfma_f32_32x32x16_bf16 v[112:127], v[76:79], v[176:179], v[112:127]
ds_read_b64_tr_b16 v[88:89], v30 offset:0
ds_read_b64_tr_b16 v[90:91], v30 offset:768
ds_read_b64_tr_b16 v[92:93], v34 offset:0
ds_read_b64_tr_b16 v[94:95], v38 offset:0
buffer_load_dwordx4 v16, s[52:55], s89 offen offset:1024 lds
s_add_u32 s77, s77, 128
s_and_b32 s77, s77, 1023
v_and_b32 v66, 15, v0
v_lshlrev_b32 v66, 3, v66
v_xor_b32 v70, 1, v70
v_lshl_add_u32 v66, v70, 7, v66
v_add_u32 v66, 157696, v66
s_waitcnt lgkmcnt(4)
v_mfma_f32_32x32x16_bf16 v[96:111], v[80:83], v[180:183], v[96:111]
v_mfma_f32_32x32x16_bf16 v[112:127], v[84:87], v[180:183], v[112:127]
ds_read_b64_tr_b16 v[72:73], v31 offset:0
ds_read_b64_tr_b16 v[74:75], v31 offset:768
ds_read_b64_tr_b16 v[76:77], v35 offset:0
ds_read_b64_tr_b16 v[78:79], v39 offset:0
s_add_u32 m0, s94, 55296
s_add_u32 s90, s90, 16384
s_cmp_eq_u32 s90, s92
s_cselect_b32 s90, s91, s90
buffer_load_dwordx4 v2, s[36:39], s90 offen lds
v_cmp_eq_u32 s[10:11], 0, v68
v_mov_b32 v70, 4294966272
s_nop 0
v_cndmask_b32 v26, v66, v69, s[10:11]
v_cndmask_b32 v27, 0, v70, s[10:11]
s_waitcnt lgkmcnt(0)
v_mfma_f32_32x32x16_bf16 v[96:111], v[88:91], v[184:187], v[96:111]
v_mfma_f32_32x32x16_bf16 v[112:127], v[92:95], v[184:187], v[112:127]
s_waitcnt vmcnt(4)
s_barrier
ds_read_b64_tr_b16 v[80:81], v28 offset:16384
ds_read_b64_tr_b16 v[82:83], v28 offset:17152
ds_read_b64_tr_b16 v[84:85], v32 offset:16384
ds_read_b64_tr_b16 v[86:87], v36 offset:16384
v_mfma_f32_32x32x16_bf16 v[96:111], v[72:75], v[188:191], v[96:111]
v_mfma_f32_32x32x16_bf16 v[112:127], v[76:79], v[188:191], v[112:127]
ds_read_b64_tr_b16 v[88:89], v29 offset:16384
ds_read_b64_tr_b16 v[90:91], v29 offset:17152
ds_read_b64_tr_b16 v[92:93], v33 offset:16384
ds_read_b64_tr_b16 v[94:95], v37 offset:16384
s_add_u32 m0, s79, 98304
s_mul_i32 s89, s77, s78
buffer_load_dwordx4 v15, s[52:55], s89 offen lds
buffer_load_dwordx4 v16, s[52:55], s89 offen offset:1024 lds
s_add_u32 s77, s77, 128
s_and_b32 s77, s77, 1023
s_lshl_b32 s82, s71, 1
s_add_u32 s82, s82, s74
s_lshr_b32 s83, s82, 2
s_lshl_b32 s83, s83, 12
s_and_b32 s82, s82, 3
s_waitcnt lgkmcnt(4)
v_mfma_f32_16x16x32_bf16 v[56:59], v[52:55], v[80:83], v[56:59]
v_mfma_f32_16x16x32_bf16 v[60:63], v[52:55], v[84:87], v[60:63]
v_mfma_f32_32x32x16_bf16 v[96:111], v[80:83], v[192:195], v[96:111]
v_mfma_f32_32x32x16_bf16 v[112:127], v[84:87], v[192:195], v[112:127]
ds_read_b64_tr_b16 v[72:73], v30 offset:16384
ds_read_b64_tr_b16 v[74:75], v30 offset:17152
ds_read_b64_tr_b16 v[76:77], v34 offset:16384
ds_read_b64_tr_b16 v[78:79], v38 offset:16384
s_add_u32 m0, s94, 57344
s_add_u32 s90, s90, 16384
s_cmp_eq_u32 s90, s92
s_cselect_b32 s90, s91, s90
buffer_load_dwordx4 v2, s[36:39], s90 offen lds
s_lshl_b32 s82, s82, 3
s_add_u32 s83, s83, s82
s_add_u32 s83, s83, 12582976
v_and_b32 v67, 1, v0
v_lshlrev_b32 v67, 5, v67
s_waitcnt lgkmcnt(4)
v_mfma_f32_32x32x16_bf16 v[96:111], v[88:91], v[196:199], v[96:111]
v_mfma_f32_32x32x16_bf16 v[112:127], v[92:95], v[196:199], v[112:127]
ds_read_b64_tr_b16 v[80:81], v31 offset:16384
ds_read_b64_tr_b16 v[82:83], v31 offset:17152
ds_read_b64_tr_b16 v[84:85], v35 offset:16384
ds_read_b64_tr_b16 v[86:87], v39 offset:16384
buffer_load_dwordx2 v[64:65], v20, s[44:47], 0 offen sc1
v_add_u32 v67, s83, v67
v_bfe_u32 v66, v0, 1, 4
v_lshl_add_u32 v21, v66, 8, v67
s_lshl_b32 s82, s73, 10
s_add_u32 s82, s82, 64
s_waitcnt lgkmcnt(0)
v_mfma_f32_32x32x16_bf16 v[96:111], v[72:75], v[200:203], v[96:111]
v_mfma_f32_32x32x16_bf16 v[112:127], v[76:79], v[200:203], v[112:127]
s_waitcnt vmcnt(5)
s_barrier
ds_read_b64_tr_b16 v[88:89], v28 offset:32768
ds_read_b64_tr_b16 v[90:91], v28 offset:33536
ds_read_b64_tr_b16 v[92:93], v32 offset:32768
ds_read_b64_tr_b16 v[94:95], v36 offset:32768
v_mfma_f32_32x32x16_bf16 v[96:111], v[80:83], v[204:207], v[96:111]
v_mfma_f32_32x32x16_bf16 v[112:127], v[84:87], v[204:207], v[112:127]
ds_read_b64_tr_b16 v[72:73], v29 offset:32768
ds_read_b64_tr_b16 v[74:75], v29 offset:33536
ds_read_b64_tr_b16 v[76:77], v33 offset:32768
ds_read_b64_tr_b16 v[78:79], v37 offset:32768
s_add_u32 m0, s79, 114688
s_mul_i32 s89, s77, s78
buffer_load_dwordx4 v15, s[52:55], s89 offen lds
v_and_b32 v66, 3, v66
v_lshl_add_u32 v22, v66, 8, v67
v_add_u32 v22, s82, v22
v_lshrrev_b32 v66, 4, v0
v_bfe_u32 v67, v0, 3, 1
s_waitcnt lgkmcnt(4)
v_mfma_f32_16x16x32_bf16 v[56:59], v[52:55], v[88:91], v[56:59]
v_mfma_f32_16x16x32_bf16 v[60:63], v[52:55], v[92:95], v[60:63]
v_mfma_f32_32x32x16_bf16 v[96:111], v[88:91], v[208:211], v[96:111]
v_mfma_f32_32x32x16_bf16 v[112:127], v[92:95], v[208:211], v[112:127]
ds_read_b64_tr_b16 v[80:81], v30 offset:32768
ds_read_b64_tr_b16 v[82:83], v30 offset:33536
ds_read_b64_tr_b16 v[84:85], v34 offset:32768
ds_read_b64_tr_b16 v[86:87], v38 offset:32768
buffer_load_dwordx4 v16, s[52:55], s89 offen offset:1024 lds
s_add_u32 s77, s77, 128
s_and_b32 s77, s77, 1023
v_lshl_add_u32 v68, v67, 2, v66
v_and_b32 v69, 7, v0
v_lshlrev_b32 v69, 4, v69
v_lshl_add_u32 v13, v68, 10, v69
s_lshl_b32 s82, s64, 2
s_waitcnt lgkmcnt(4)
v_mfma_f32_32x32x16_bf16 v[96:111], v[72:75], v[212:215], v[96:111]
v_mfma_f32_32x32x16_bf16 v[112:127], v[76:79], v[212:215], v[112:127]
ds_read_b64_tr_b16 v[88:89], v31 offset:32768
ds_read_b64_tr_b16 v[90:91], v31 offset:33536
ds_read_b64_tr_b16 v[92:93], v35 offset:32768
ds_read_b64_tr_b16 v[94:95], v39 offset:32768
s_add_u32 m0, s94, 59392
s_add_u32 s90, s90, 16384
s_cmp_eq_u32 s90, s92
s_cselect_b32 s90, s91, s90
buffer_load_dwordx4 v2, s[36:39], s90 offen lds
v_add_u32 v66, s82, v66
v_mul_u32_u24 v66, 272, v66
v_lshl_add_u32 v66, v67, 7, v66
v_and_b32 v67, 3, v0
v_lshl_add_u32 v66, v67, 5, v66
s_waitcnt lgkmcnt(0)
v_mfma_f32_32x32x16_bf16 v[96:111], v[80:83], v[216:219], v[96:111]
v_mfma_f32_32x32x16_bf16 v[112:127], v[84:87], v[216:219], v[112:127]
s_waitcnt vmcnt(5)
s_barrier
ds_read_b64_tr_b16 v[72:73], v28 offset:0
ds_read_b64_tr_b16 v[74:75], v28 offset:768
ds_read_b64_tr_b16 v[76:77], v32 offset:0
ds_read_b64_tr_b16 v[78:79], v36 offset:0
v_mfma_f32_32x32x16_bf16 v[96:111], v[88:91], v[220:223], v[96:111]
v_mfma_f32_32x32x16_bf16 v[112:127], v[92:95], v[220:223], v[112:127]
ds_read_b64_tr_b16 v[80:81], v29 offset:0
ds_read_b64_tr_b16 v[82:83], v29 offset:768
ds_read_b64_tr_b16 v[84:85], v33 offset:0
ds_read_b64_tr_b16 v[86:87], v37 offset:0
s_waitcnt vmcnt(3)
v_cmp_ne_u64 vcc, s[84:85], v[64:65]
s_cbranch_vccnz Lsp_2
Lspe_3:
s_add_u32 m0, s15, 0
s_nop 0
buffer_load_dwordx4 v1, s[44:47], s12 offen sc1 lds
v_bfe_u32 v67, v0, 2, 1
v_mul_u32_u24 v67, 8704, v67
v_add_u32 v14, v66, v67
v_and_b32 v6, 31, v0
s_lshl_b32 s82, s68, 10
s_waitcnt lgkmcnt(4)
v_mfma_f32_16x16x32_bf16 v[56:59], v[52:55], v[72:75], v[56:59]
v_mfma_f32_16x16x32_bf16 v[60:63], v[52:55], v[76:79], v[60:63]
v_mfma_f32_32x32x16_bf16 v[96:111], v[72:75], v[224:227], v[96:111]
v_mfma_f32_32x32x16_bf16 v[112:127], v[76:79], v[224:227], v[112:127]
ds_read_b64_tr_b16 v[88:89], v30 offset:0
ds_read_b64_tr_b16 v[90:91], v30 offset:768
ds_read_b64_tr_b16 v[92:93], v34 offset:0
ds_read_b64_tr_b16 v[94:95], v38 offset:0
s_add_u32 m0, s15, 12288
s_nop 0
buffer_load_dwordx4 v12, s[44:47], s12 offen sc1 lds
s_lshl_b32 s83, s67, 2
s_add_u32 s82, s82, s83
s_add_u32 s82, s82, 155648
v_lshl_add_u32 v8, v6, 4, s82
v_subrev_u32 v7, s83, v8
s_waitcnt lgkmcnt(4)
v_mfma_f32_32x32x16_bf16 v[96:111], v[80:83], v[228:231], v[96:111]
v_mfma_f32_32x32x16_bf16 v[112:127], v[84:87], v[228:231], v[112:127]
ds_read_b64_tr_b16 v[72:73], v31 offset:0
ds_read_b64_tr_b16 v[74:75], v31 offset:768
ds_read_b64_tr_b16 v[76:77], v35 offset:0
ds_read_b64_tr_b16 v[78:79], v39 offset:0
s_add_u32 m0, s15, 4096
s_nop 0
buffer_load_dwordx4 v1, s[44:47], s13 offen sc1 lds
v_mov_b32 v136, 0
v_mov_b32 v137, 0
v_mov_b32 v138, 0
v_mov_b32 v139, 0
v_mov_b32 v140, 0
s_waitcnt lgkmcnt(0)
v_mfma_f32_32x32x16_bf16 v[96:111], v[88:91], v[232:235], v[96:111]
v_mfma_f32_32x32x16_bf16 v[112:127], v[92:95], v[232:235], v[112:127]
s_waitcnt vmcnt(4)
s_barrier
ds_read_b64_tr_b16 v[80:81], v28 offset:16384
ds_read_b64_tr_b16 v[82:83], v28 offset:17152
ds_read_b64_tr_b16 v[84:85], v32 offset:16384
ds_read_b64_tr_b16 v[86:87], v36 offset:16384
v_mfma_f32_32x32x16_bf16 v[96:111], v[72:75], v[236:239], v[96:111]
v_mfma_f32_32x32x16_bf16 v[112:127], v[76:79], v[236:239], v[112:127]
ds_read_b64_tr_b16 v[88:89], v29 offset:16384
ds_read_b64_tr_b16 v[90:91], v29 offset:17152
ds_read_b64_tr_b16 v[92:93], v33 offset:16384
ds_read_b64_tr_b16 v[94:95], v37 offset:16384
s_add_u32 m0, s15, 16384
s_nop 0
buffer_load_dwordx4 v12, s[44:47], s13 offen sc1 lds
v_mov_b32 v141, 0
v_mov_b32 v142, 0
v_mov_b32 v143, 0
v_mov_b32 v144, 0
v_mov_b32 v145, 0
s_waitcnt lgkmcnt(4)
v_mfma_f32_16x16x32_bf16 v[56:59], v[52:55], v[80:83], v[56:59]
v_mfma_f32_16x16x32_bf16 v[60:63], v[52:55], v[84:87], v[60:63]
v_mfma_f32_32x32x16_bf16 v[96:111], v[80:83], v[240:243], v[96:111]
v_mfma_f32_32x32x16_bf16 v[112:127], v[84:87], v[240:243], v[112:127]
ds_read_b64_tr_b16 v[72:73], v30 offset:16384
ds_read_b64_tr_b16 v[74:75], v30 offset:17152
ds_read_b64_tr_b16 v[76:77], v34 offset:16384
ds_read_b64_tr_b16 v[78:79], v38 offset:16384
s_add_u32 m0, s15, 8192
s_nop 0
buffer_load_dwordx4 v1, s[44:47], s14 offen sc1 lds
v_mov_b32 v146, 0
v_mov_b32 v147, 0
v_mov_b32 v148, 0
v_mov_b32 v149, 0
v_mov_b32 v150, 0
s_waitcnt lgkmcnt(4)
v_mfma_f32_32x32x16_bf16 v[96:111], v[88:91], v[244:247], v[96:111]
v_mfma_f32_32x32x16_bf16 v[112:127], v[92:95], v[244:247], v[112:127]
ds_read_b64_tr_b16 v[80:81], v31 offset:16384
ds_read_b64_tr_b16 v[82:83], v31 offset:17152
ds_read_b64_tr_b16 v[84:85], v35 offset:16384
ds_read_b64_tr_b16 v[86:87], v39 offset:16384
s_add_u32 m0, s15, 20480
s_nop 0
buffer_load_dwordx4 v12, s[44:47], s14 offen sc1 lds
v_mov_b32 v151, 0
ds_write_b32 v8, v56
ds_write_b32 v8, v60 offset:512
s_waitcnt lgkmcnt(0)
v_mfma_f32_32x32x16_bf16 v[96:111], v[72:75], v[248:251], v[96:111]
v_mfma_f32_32x32x16_bf16 v[112:127], v[76:79], v[248:251], v[112:127]
s_waitcnt vmcnt(6)
s_barrier
ds_read_b128 v[56:59], v7
ds_read_b128 v[60:63], v7 offset:512
v_mfma_f32_32x32x16_bf16 v[96:111], v[80:83], v[252:255], v[96:111]
v_mfma_f32_32x32x16_bf16 v[112:127], v[84:87], v[252:255], v[112:127]
v_add_u32 v34, 49152, v23
s_add_u32 m0, s94, 98304
s_add_u32 s90, s90, 16384
s_cmp_eq_u32 s90, s92
s_cselect_b32 s90, s91, s90
buffer_load_dwordx4 v2, s[36:39], s90 offen lds
s_waitcnt vmcnt(31) lgkmcnt(0)
v_add_f32 v60, v60, v61
v_add_f32 v62, v62, v63
v_add_f32 v60, v60, v62
v_cvt_pk_bf16_f32 v48, v60, v60
v_and_b32 v61, 0xffff0000, v48
v_sub_f32 v61, v60, v61
v_cvt_pk_bf16_f32 v49, v61, 0
v_lshl_or_b32 v49, v18, 16, v49
v_mov_b32 v50, v18
v_mov_b32 v51, 0
v_add_f32 v56, v56, v57
v_add_f32 v58, v58, v59
v_add_f32 v56, v56, v58
v_cvt_pk_bf16_f32 v44, v56, v56
v_and_b32 v57, 0xffff0000, v44
v_sub_f32 v57, v56, v57
v_cvt_pk_bf16_f32 v45, v57, 0
v_lshl_or_b32 v45, v17, 16, v45
v_mov_b32 v46, v17
v_mov_b32 v47, 0
v_mfma_f32_32x32x16_bf16 v[112:127], v[48:51], v[40:43], v[112:127]
v_add_u32 v28, 147456, v1
v_mfma_f32_32x32x16_bf16 v[96:111], v[44:47], v[40:43], v[96:111]
s_add_u32 m0, s94, 100352
s_add_u32 s90, s90, 16384
s_cmp_eq_u32 s90, s92
s_cselect_b32 s90, s91, s90
buffer_load_dwordx4 v2, s[36:39], s90 offen lds
ds_read_b64_tr_b16 v[160:161], v34 offset:0
ds_read_b64_tr_b16 v[162:163], v34 offset:1024
ds_read_b64_tr_b16 v[164:165], v34 offset:2048
ds_read_b64_tr_b16 v[166:167], v34 offset:3072
v_add_u32 v29, s4, v1
v_add_u32 v30, 0x10000, v29
s_lshl_b32 s82, s67, 10
s_add_u32 s82, s82, 159744
v_add_u32 v8, s82, v1
s_cmp_lg_u32 s68, 0
s_cbranch_scc1 Lqe_4
v_mul_f32 v19, 0x3eb8aa3b, v19
v_pk_mul_f32 v[112:113], v[112:113], v[18:19] op_sel:[0,1] op_sel_hi:[1,1]
v_pk_mul_f32 v[114:115], v[114:115], v[18:19] op_sel:[0,1] op_sel_hi:[1,1]
v_pk_mul_f32 v[116:117], v[116:117], v[18:19] op_sel:[0,1] op_sel_hi:[1,1]
v_pk_mul_f32 v[118:119], v[118:119], v[18:19] op_sel:[0,1] op_sel_hi:[1,1]
v_pk_mul_f32 v[120:121], v[120:121], v[18:19] op_sel:[0,1] op_sel_hi:[1,1]
v_pk_mul_f32 v[122:123], v[122:123], v[18:19] op_sel:[0,1] op_sel_hi:[1,1]
v_pk_mul_f32 v[124:125], v[124:125], v[18:19] op_sel:[0,1] op_sel_hi:[1,1]
v_pk_mul_f32 v[126:127], v[126:127], v[18:19] op_sel:[0,1] op_sel_hi:[1,1]
v_cvt_pk_bf16_f32 v44, v112, v113
v_cvt_pk_bf16_f32 v45, v114, v115
v_cvt_pk_bf16_f32 v46, v116, v117
v_cvt_pk_bf16_f32 v47, v118, v119
v_cvt_pk_bf16_f32 v112, v120, v121
v_cvt_pk_bf16_f32 v113, v122, v123
v_cvt_pk_bf16_f32 v114, v124, v125
v_cvt_pk_bf16_f32 v115, v126, v127
ds_write_b128 v8, v[112:115]
Lqe_4:
s_nop 1
v_pk_mul_f32 v[128:129], v[96:97], v[96:97]
v_pk_mul_f32 v[130:131], v[98:99], v[98:99]
v_pk_mul_f32 v[132:133], v[100:101], v[100:101]
v_pk_mul_f32 v[134:135], v[102:103], v[102:103]
v_pk_fma_f32 v[128:129], v[128:129], v[10:11], v[8:9] op_sel:[0,0,1] op_sel_hi:[1,0,1]
v_pk_fma_f32 v[130:131], v[130:131], v[10:11], v[8:9] op_sel:[0,0,1] op_sel_hi:[1,0,1]
v_pk_fma_f32 v[132:133], v[132:133], v[10:11], v[8:9] op_sel:[0,0,1] op_sel_hi:[1,0,1]
v_pk_fma_f32 v[134:135], v[134:135], v[10:11], v[8:9] op_sel:[0,0,1] op_sel_hi:[1,0,1]
v_pk_mul_f32 v[128:129], v[128:129], v[96:97]
v_pk_mul_f32 v[130:131], v[130:131], v[98:99]
v_pk_mul_f32 v[132:133], v[132:133], v[100:101]
v_pk_mul_f32 v[134:135], v[134:135], v[102:103]
s_add_u32 m0, s94, 102400
s_add_u32 s90, s90, 16384
s_cmp_eq_u32 s90, s92
s_cselect_b32 s90, s91, s90
buffer_load_dwordx4 v2, s[36:39], s90 offen lds
ds_read_b64_tr_b16 v[168:169], v34 offset:4096
ds_read_b64_tr_b16 v[170:171], v34 offset:5120
v_exp_f32 v128, v128
v_exp_f32 v129, v129
v_exp_f32 v130, v130
v_exp_f32 v131, v131
v_exp_f32 v132, v132
v_exp_f32 v133, v133
v_exp_f32 v134, v134
v_exp_f32 v135, v135
v_pk_fma_f32 v[128:129], v[128:129], v[10:11], v[10:11] op_sel:[0,1,1] op_sel_hi:[1,1,1]
v_pk_fma_f32 v[130:131], v[130:131], v[10:11], v[10:11] op_sel:[0,1,1] op_sel_hi:[1,1,1]
v_pk_fma_f32 v[132:133], v[132:133], v[10:11], v[10:11] op_sel:[0,1,1] op_sel_hi:[1,1,1]
v_pk_fma_f32 v[134:135], v[134:135], v[10:11], v[10:11] op_sel:[0,1,1] op_sel_hi:[1,1,1]
s_add_u32 m0, s94, 104448
s_add_u32 s90, s90, 16384
s_cmp_eq_u32 s90, s92
s_cselect_b32 s90, s91, s90
buffer_load_dwordx4 v2, s[36:39], s90 offen lds
ds_read_b64_tr_b16 v[172:173], v34 offset:6144
ds_read_b64_tr_b16 v[174:175], v34 offset:7168
v_rcp_f32 v128, v128
v_rcp_f32 v129, v129
v_rcp_f32 v130, v130
v_rcp_f32 v131, v131
v_rcp_f32 v132, v132
v_rcp_f32 v133, v133
v_rcp_f32 v134, v134
v_rcp_f32 v135, v135
v_pk_mul_f32 v[96:97], v[128:129], v[96:97]
v_pk_mul_f32 v[98:99], v[130:131], v[98:99]
v_pk_mul_f32 v[100:101], v[132:133], v[100:101]
v_pk_mul_f32 v[102:103], v[134:135], v[102:103]
v_cvt_pk_bf16_f32 v96, v96, v97
v_cvt_pk_bf16_f32 v97, v98, v99
v_cvt_pk_bf16_f32 v98, v100, v101
v_cvt_pk_bf16_f32 v99, v102, v103
buffer_store_dwordx4 v[96:99], v1, s[44:47], s20 offen offset:0 sc1
v_pk_mul_f32 v[128:129], v[104:105], v[104:105]
v_pk_mul_f32 v[130:131], v[106:107], v[106:107]
v_pk_mul_f32 v[132:133], v[108:109], v[108:109]
v_pk_mul_f32 v[134:135], v[110:111], v[110:111]
v_pk_fma_f32 v[128:129], v[128:129], v[10:11], v[8:9] op_sel:[0,0,1] op_sel_hi:[1,0,1]
v_pk_fma_f32 v[130:131], v[130:131], v[10:11], v[8:9] op_sel:[0,0,1] op_sel_hi:[1,0,1]
v_pk_fma_f32 v[132:133], v[132:133], v[10:11], v[8:9] op_sel:[0,0,1] op_sel_hi:[1,0,1]
v_pk_fma_f32 v[134:135], v[134:135], v[10:11], v[8:9] op_sel:[0,0,1] op_sel_hi:[1,0,1]
v_pk_mul_f32 v[128:129], v[128:129], v[104:105]
v_pk_mul_f32 v[130:131], v[130:131], v[106:107]
v_pk_mul_f32 v[132:133], v[132:133], v[108:109]
v_pk_mul_f32 v[134:135], v[134:135], v[110:111]
s_add_u32 m0, s94, 106496
s_add_u32 s90, s90, 16384
s_cmp_eq_u32 s90, s92
s_cselect_b32 s90, s91, s90
buffer_load_dwordx4 v2, s[36:39], s90 offen lds
ds_read_b64_tr_b16 v[176:177], v34 offset:8192
ds_read_b64_tr_b16 v[178:179], v34 offset:9216
v_exp_f32 v128, v128
v_exp_f32 v129, v129
v_exp_f32 v130, v130
v_exp_f32 v131, v131
v_exp_f32 v132, v132
v_exp_f32 v133, v133
v_exp_f32 v134, v134
v_exp_f32 v135, v135
v_pk_fma_f32 v[128:129], v[128:129], v[10:11], v[10:11] op_sel:[0,1,1] op_sel_hi:[1,1,1]
v_pk_fma_f32 v[130:131], v[130:131], v[10:11], v[10:11] op_sel:[0,1,1] op_sel_hi:[1,1,1]
v_pk_fma_f32 v[132:133], v[132:133], v[10:11], v[10:11] op_sel:[0,1,1] op_sel_hi:[1,1,1]
v_pk_fma_f32 v[134:135], v[134:135], v[10:11], v[10:11] op_sel:[0,1,1] op_sel_hi:[1,1,1]
s_add_u32 m0, s94, 108544
s_add_u32 s90, s90, 16384
s_cmp_eq_u32 s90, s92
s_cselect_b32 s90, s91, s90
buffer_load_dwordx4 v2, s[36:39], s90 offen lds
ds_read_b64_tr_b16 v[180:181], v34 offset:10240
ds_read_b64_tr_b16 v[182:183], v34 offset:11264
v_rcp_f32 v128, v128
v_rcp_f32 v129, v129
v_rcp_f32 v130, v130
v_rcp_f32 v131, v131
v_rcp_f32 v132, v132
v_rcp_f32 v133, v133
v_rcp_f32 v134, v134
v_rcp_f32 v135, v135
v_pk_mul_f32 v[104:105], v[128:129], v[104:105]
v_pk_mul_f32 v[106:107], v[130:131], v[106:107]
v_pk_mul_f32 v[108:109], v[132:133], v[108:109]
v_pk_mul_f32 v[110:111], v[134:135], v[110:111]
v_cvt_pk_bf16_f32 v104, v104, v105
v_cvt_pk_bf16_f32 v105, v106, v107
v_cvt_pk_bf16_f32 v106, v108, v109
v_cvt_pk_bf16_f32 v107, v110, v111
buffer_store_dwordx4 v[104:107], v1, s[44:47], s20 offen offset:1024 sc1
s_waitcnt vmcnt(8) lgkmcnt(0)
s_barrier
ds_read_b128 v[48:51], v25 offset:8192
ds_read_b128 v[72:75], v28 offset:0
ds_read_b128 v[76:79], v28 offset:1024
ds_read_b128 v[80:83], v28 offset:2048
ds_read_b128 v[84:87], v28 offset:3072
ds_read_b128 v[52:55], v25 offset:7168
ds_read_b64_tr_b16 v[56:57], v26 offset:0
ds_read_b64_tr_b16 v[58:59], v26 offset:256
ds_read_b64_tr_b16 v[60:61], v26 offset:512
ds_read_b64_tr_b16 v[62:63], v26 offset:768
s_cmp_eq_u32 s68, 0
s_cbranch_scc1 Lg2_5
ds_read_b128 v[44:47], v8
s_cmp_ge_u32 s66, 11
s_cbranch_scc1 Lg2_5
s_setprio 1
v_pk_mul_f32 v[128:129], v[112:113], v[112:113]
v_pk_mul_f32 v[130:131], v[114:115], v[114:115]
v_pk_mul_f32 v[132:133], v[116:117], v[116:117]
v_pk_mul_f32 v[134:135], v[118:119], v[118:119]
v_pk_fma_f32 v[128:129], v[128:129], v[10:11], v[8:9] op_sel:[0,0,1] op_sel_hi:[1,0,1]
v_pk_fma_f32 v[130:131], v[130:131], v[10:11], v[8:9] op_sel:[0,0,1] op_sel_hi:[1,0,1]
v_pk_fma_f32 v[132:133], v[132:133], v[10:11], v[8:9] op_sel:[0,0,1] op_sel_hi:[1,0,1]
v_pk_fma_f32 v[134:135], v[134:135], v[10:11], v[8:9] op_sel:[0,0,1] op_sel_hi:[1,0,1]
v_pk_mul_f32 v[128:129], v[128:129], v[112:113]
v_pk_mul_f32 v[130:131], v[130:131], v[114:115]
v_pk_mul_f32 v[132:133], v[132:133], v[116:117]
v_pk_mul_f32 v[134:135], v[134:135], v[118:119]
v_exp_f32 v128, v128
v_exp_f32 v129, v129
v_exp_f32 v130, v130
v_exp_f32 v131, v131
v_exp_f32 v132, v132
v_exp_f32 v133, v133
v_exp_f32 v134, v134
v_exp_f32 v135, v135
v_pk_fma_f32 v[128:129], v[128:129], v[10:11], v[10:11] op_sel:[0,1,1] op_sel_hi:[1,1,1]
v_pk_fma_f32 v[130:131], v[130:131], v[10:11], v[10:11] op_sel:[0,1,1] op_sel_hi:[1,1,1]
v_pk_fma_f32 v[132:133], v[132:133], v[10:11], v[10:11] op_sel:[0,1,1] op_sel_hi:[1,1,1]
v_pk_fma_f32 v[134:135], v[134:135], v[10:11], v[10:11] op_sel:[0,1,1] op_sel_hi:[1,1,1]
v_rcp_f32 v128, v128
v_rcp_f32 v129, v129
v_rcp_f32 v130, v130
v_rcp_f32 v131, v131
v_rcp_f32 v132, v132
v_rcp_f32 v133, v133
v_rcp_f32 v134, v134
v_rcp_f32 v135, v135
v_pk_mul_f32 v[112:113], v[128:129], v[112:113]
v_pk_mul_f32 v[114:115], v[130:131], v[114:115]
v_pk_mul_f32 v[116:117], v[132:133], v[116:117]
v_pk_mul_f32 v[118:119], v[134:135], v[118:119]
v_cvt_pk_bf16_f32 v112, v112, v113
v_cvt_pk_bf16_f32 v113, v114, v115
v_cvt_pk_bf16_f32 v114, v116, v117
v_cvt_pk_bf16_f32 v115, v118, v119
buffer_store_dwordx4 v[112:115], v1, s[44:47], s20 offen offset:2048 sc1
v_pk_mul_f32 v[128:129], v[120:121], v[120:121]
v_pk_mul_f32 v[130:131], v[122:123], v[122:123]
v_pk_mul_f32 v[132:133], v[124:125], v[124:125]
v_pk_mul_f32 v[134:135], v[126:127], v[126:127]
v_pk_fma_f32 v[128:129], v[128:129], v[10:11], v[8:9] op_sel:[0,0,1] op_sel_hi:[1,0,1]
v_pk_fma_f32 v[130:131], v[130:131], v[10:11], v[8:9] op_sel:[0,0,1] op_sel_hi:[1,0,1]
v_pk_fma_f32 v[132:133], v[132:133], v[10:11], v[8:9] op_sel:[0,0,1] op_sel_hi:[1,0,1]
v_pk_fma_f32 v[134:135], v[134:135], v[10:11], v[8:9] op_sel:[0,0,1] op_sel_hi:[1,0,1]
v_pk_mul_f32 v[128:129], v[128:129], v[120:121]
v_pk_mul_f32 v[130:131], v[130:131], v[122:123]
v_pk_mul_f32 v[132:133], v[132:133], v[124:125]
v_pk_mul_f32 v[134:135], v[134:135], v[126:127]
v_exp_f32 v128, v128
v_exp_f32 v129, v129
v_exp_f32 v130, v130
v_exp_f32 v131, v131
v_exp_f32 v132, v132
v_exp_f32 v133, v133
v_exp_f32 v134, v134
v_exp_f32 v135, v135
v_pk_fma_f32 v[128:129], v[128:129], v[10:11], v[10:11] op_sel:[0,1,1] op_sel_hi:[1,1,1]
v_pk_fma_f32 v[130:131], v[130:131], v[10:11], v[10:11] op_sel:[0,1,1] op_sel_hi:[1,1,1]
v_pk_fma_f32 v[132:133], v[132:133], v[10:11], v[10:11] op_sel:[0,1,1] op_sel_hi:[1,1,1]
v_pk_fma_f32 v[134:135], v[134:135], v[10:11], v[10:11] op_sel:[0,1,1] op_sel_hi:[1,1,1]
v_rcp_f32 v128, v128
v_rcp_f32 v129, v129
v_rcp_f32 v130, v130
v_rcp_f32 v131, v131
v_rcp_f32 v132, v132
v_rcp_f32 v133, v133
v_rcp_f32 v134, v134
v_rcp_f32 v135, v135
v_pk_mul_f32 v[120:121], v[128:129], v[120:121]
v_pk_mul_f32 v[122:123], v[130:131], v[122:123]
v_pk_mul_f32 v[124:125], v[132:133], v[124:125]
v_pk_mul_f32 v[126:127], v[134:135], v[126:127]
v_cvt_pk_bf16_f32 v120, v120, v121
v_cvt_pk_bf16_f32 v121, v122, v123
v_cvt_pk_bf16_f32 v122, v124, v125
v_cvt_pk_bf16_f32 v123, v126, v127
buffer_store_dwordx4 v[120:123], v1, s[44:47], s20 offen offset:3072 sc1
s_setprio 0
Lg2_5:
s_waitcnt lgkmcnt(0)
v_mfma_f32_32x32x16_bf16 v[72:87], v[48:51], v[44:47], v[72:87]
s_add_u32 m0, s94, 49152
s_add_u32 s90, s90, 16384
s_cmp_eq_u32 s90, s92
s_cselect_b32 s90, s91, s90
buffer_load_dwordx4 v2, s[36:39], s90 offen lds
s_nop 3
s_waitcnt lgkmcnt(0)
s_cmp_eq_u32 s75, 0
s_cbranch_scc1 Lmsk_6
Lmsk_6r:
v_add_u32 v26, v26, v27
v_mfma_f32_32x32x16_bf16 v[88:103], v[52:55], v[44:47], v[136:151]
ds_read_b128 v[48:51], v25 offset:6144
ds_read_b64_tr_b16 v[64:65], v26 offset:0
ds_read_b64_tr_b16 v[66:67], v26 offset:256
ds_read_b64_tr_b16 v[68:69], v26 offset:512
ds_read_b64_tr_b16 v[70:71], v26 offset:768
v_exp_f32 v72, v72
v_exp_f32 v73, v73
v_exp_f32 v74, v74
v_exp_f32 v75, v75
v_exp_f32 v76, v76
v_exp_f32 v77, v77
v_exp_f32 v78, v78
v_exp_f32 v79, v79
s_add_u32 m0, s94, 51200
s_add_u32 s90, s90, 16384
s_cmp_eq_u32 s90, s92
s_cselect_b32 s90, s91, s90
buffer_load_dwordx4 v2, s[36:39], s90 offen lds
v_cvt_pk_bf16_f32 v104, v72, v73
v_cvt_pk_bf16_f32 v105, v74, v75
v_cvt_pk_bf16_f32 v106, v76, v77
v_cvt_pk_bf16_f32 v107, v78, v79
v_exp_f32 v80, v80
v_exp_f32 v81, v81
v_exp_f32 v82, v82
v_exp_f32 v83, v83
v_mfma_f32_32x32x16_bf16 v[112:127], v[56:59], v[104:107], 0
s_add_u32 m0, s94, 53248
s_add_u32 s90, s90, 16384
s_cmp_eq_u32 s90, s92
s_cselect_b32 s90, s91, s90
buffer_load_dwordx4 v2, s[36:39], s90 offen lds
v_exp_f32 v84, v84
v_exp_f32 v85, v85
v_exp_f32 v86, v86
v_exp_f32 v87, v87
s_add_u32 m0, s94, 55296
s_add_u32 s90, s90, 16384
s_cmp_eq_u32 s90, s92
s_cselect_b32 s90, s91, s90
buffer_load_dwordx4 v2, s[36:39], s90 offen lds
v_cvt_pk_bf16_f32 v108, v80, v81
v_cvt_pk_bf16_f32 v109, v82, v83
v_cvt_pk_bf16_f32 v110, v84, v85
v_cvt_pk_bf16_f32 v111, v86, v87
s_waitcnt vmcnt(5)
s_barrier
v_add_u32 v34, 98304, v23
s_waitcnt lgkmcnt(0)
s_cmp_eq_u32 s75, 1
s_cbranch_scc1 Lmsk_7
Lmsk_7r:
v_mfma_f32_32x32x16_bf16 v[112:127], v[60:63], v[108:111], v[112:127]
v_add_u32 v26, v26, v27
v_mfma_f32_32x32x16_bf16 v[72:87], v[48:51], v[44:47], v[136:151]
ds_read_b128 v[52:55], v25 offset:5120
ds_read_b64_tr_b16 v[56:57], v26 offset:0
ds_read_b64_tr_b16 v[58:59], v26 offset:256
ds_read_b64_tr_b16 v[60:61], v26 offset:512
ds_read_b64_tr_b16 v[62:63], v26 offset:768
v_exp_f32 v88, v88
v_exp_f32 v89, v89
v_exp_f32 v90, v90
v_exp_f32 v91, v91
v_exp_f32 v92, v92
v_exp_f32 v93, v93
v_exp_f32 v94, v94
v_exp_f32 v95, v95
s_add_u32 m0, s94, 57344
s_add_u32 s90, s90, 16384
s_cmp_eq_u32 s90, s92
s_cselect_b32 s90, s91, s90
buffer_load_dwordx4 v2, s[36:39], s90 offen lds
ds_read_b64_tr_b16 v[184:185], v34 offset:0
ds_read_b64_tr_b16 v[186:187], v34 offset:1024
ds_read_b64_tr_b16 v[188:189], v34 offset:2048
ds_read_b64_tr_b16 v[190:191], v34 offset:3072
v_cvt_pk_bf16_f32 v104, v88, v89
v_cvt_pk_bf16_f32 v105, v90, v91
v_cvt_pk_bf16_f32 v106, v92, v93
v_cvt_pk_bf16_f32 v107, v94, v95
v_exp_f32 v96, v96
v_exp_f32 v97, v97
v_exp_f32 v98, v98
v_exp_f32 v99, v99
v_mfma_f32_32x32x16_bf16 v[112:127], v[64:67], v[104:107], v[112:127]
ds_read_b64_tr_b16 v[192:193], v34 offset:4096
ds_read_b64_tr_b16 v[194:195], v34 offset:5120
ds_read_b64_tr_b16 v[196:197], v34 offset:6144
ds_read_b64_tr_b16 v[198:199], v34 offset:7168
s_add_u32 m0, s94, 59392
s_add_u32 s90, s90, 16384
s_cmp_eq_u32 s90, s92
s_cselect_b32 s90, s91, s90
buffer_load_dwordx4 v2, s[36:39], s90 offen lds
v_exp_f32 v100, v100
v_exp_f32 v101, v101
v_exp_f32 v102, v102
v_exp_f32 v103, v103
ds_read_b64_tr_b16 v[200:201], v34 offset:8192
ds_read_b64_tr_b16 v[202:203], v34 offset:9216
ds_read_b64_tr_b16 v[204:205], v34 offset:10240
ds_read_b64_tr_b16 v[206:207], v34 offset:11264
v_cvt_pk_bf16_f32 v108, v96, v97
v_cvt_pk_bf16_f32 v109, v98, v99
v_cvt_pk_bf16_f32 v110, v100, v101
v_cvt_pk_bf16_f32 v111, v102, v103
s_waitcnt lgkmcnt(0)
s_barrier
s_waitcnt vmcnt(6)
s_mov_b64 exec, 1
buffer_store_dwordx2 v[4:5], off, s[44:47], s81 offset:64 sc1
s_mov_b64 exec, -1
s_waitcnt lgkmcnt(12)
s_cmp_eq_u32 s75, 2
s_cbranch_scc1 Lmsk_8
Lmsk_8r:
v_mfma_f32_32x32x16_bf16 v[112:127], v[68:71], v[108:111], v[112:127]
v_add_u32 v26, v26, v27
v_mfma_f32_32x32x16_bf16 v[88:103], v[52:55], v[44:47], v[136:151]
ds_read_b128 v[48:51], v25 offset:4096
ds_read_b64_tr_b16 v[64:65], v26 offset:0
ds_read_b64_tr_b16 v[66:67], v26 offset:256
ds_read_b64_tr_b16 v[68:69], v26 offset:512
ds_read_b64_tr_b16 v[70:71], v26 offset:768
v_exp_f32 v72, v72
v_exp_f32 v73, v73
v_exp_f32 v74, v74
v_exp_f32 v75, v75
v_exp_f32 v76, v76
v_exp_f32 v77, v77
v_exp_f32 v78, v78
v_exp_f32 v79, v79
s_add_u32 m0, s94, 98304
s_add_u32 s90, s90, 16384
s_cmp_eq_u32 s90, s92
s_cselect_b32 s90, s91, s90
buffer_load_dwordx4 v2, s[36:39], s90 offen lds
v_cvt_pk_bf16_f32 v104, v72, v73
v_cvt_pk_bf16_f32 v105, v74, v75
v_cvt_pk_bf16_f32 v106, v76, v77
v_cvt_pk_bf16_f32 v107, v78, v79
v_exp_f32 v80, v80
v_exp_f32 v81, v81
v_exp_f32 v82, v82
v_exp_f32 v83, v83
v_mfma_f32_32x32x16_bf16 v[112:127], v[56:59], v[104:107], v[112:127]
s_add_u32 m0, s94, 100352
s_add_u32 s90, s90, 16384
s_cmp_eq_u32 s90, s92
s_cselect_b32 s90, s91, s90
buffer_load_dwordx4 v2, s[36:39], s90 offen lds
v_exp_f32 v84, v84
v_exp_f32 v85, v85
v_exp_f32 v86, v86
v_exp_f32 v87, v87
s_add_u32 m0, s94, 102400
s_add_u32 s90, s90, 16384
s_cmp_eq_u32 s90, s92
s_cselect_b32 s90, s91, s90
buffer_load_dwordx4 v2, s[36:39], s90 offen lds
v_cvt_pk_bf16_f32 v108, v80, v81
v_cvt_pk_bf16_f32 v109, v82, v83
v_cvt_pk_bf16_f32 v110, v84, v85
v_cvt_pk_bf16_f32 v111, v86, v87
s_waitcnt lgkmcnt(0)
s_cmp_eq_u32 s75, 3
s_cbranch_scc1 Lmsk_9
Lmsk_9r:
v_mfma_f32_32x32x16_bf16 v[112:127], v[60:63], v[108:111], v[112:127]
v_add_u32 v26, v26, v27
v_mfma_f32_32x32x16_bf16 v[72:87], v[48:51], v[44:47], v[136:151]
ds_read_b128 v[52:55], v25 offset:3072
ds_read_b64_tr_b16 v[56:57], v26 offset:0
ds_read_b64_tr_b16 v[58:59], v26 offset:256
ds_read_b64_tr_b16 v[60:61], v26 offset:512
ds_read_b64_tr_b16 v[62:63], v26 offset:768
v_exp_f32 v88, v88
v_exp_f32 v89, v89
v_exp_f32 v90, v90
v_exp_f32 v91, v91
v_exp_f32 v92, v92
v_exp_f32 v93, v93
v_exp_f32 v94, v94
v_exp_f32 v95, v95
s_add_u32 m0, s94, 104448
s_add_u32 s90, s90, 16384
s_cmp_eq_u32 s90, s92
s_cselect_b32 s90, s91, s90
buffer_load_dwordx4 v2, s[36:39], s90 offen lds
v_cvt_pk_bf16_f32 v104, v88, v89
v_cvt_pk_bf16_f32 v105, v90, v91
v_cvt_pk_bf16_f32 v106, v92, v93
v_cvt_pk_bf16_f32 v107, v94, v95
v_exp_f32 v96, v96
v_exp_f32 v97, v97
v_exp_f32 v98, v98
v_exp_f32 v99, v99
v_mfma_f32_32x32x16_bf16 v[112:127], v[64:67], v[104:107], v[112:127]
s_add_u32 m0, s94, 106496
s_lshl_b32 s89, s73, 17
s_or_b32 s89, s89, s93
buffer_load_dwordx4 v2, s[40:43], s89 offen lds
v_exp_f32 v100, v100
v_exp_f32 v101, v101
v_exp_f32 v102, v102
v_exp_f32 v103, v103
s_add_u32 m0, s94, 108544
s_add_u32 s93, s93, 16384
s_and_b32 s93, s93, 0x1ffff
s_lshl_b32 s89, s73, 17
s_or_b32 s89, s89, s93
buffer_load_dwordx4 v2, s[40:43], s89 offen lds
v_cvt_pk_bf16_f32 v108, v96, v97
v_cvt_pk_bf16_f32 v109, v98, v99
v_cvt_pk_bf16_f32 v110, v100, v101
v_cvt_pk_bf16_f32 v111, v102, v103
s_waitcnt lgkmcnt(0)
s_cmp_eq_u32 s75, 4
s_cbranch_scc1 Lmsk_10
Lmsk_10r:
v_mfma_f32_32x32x16_bf16 v[112:127], v[68:71], v[108:111], v[112:127]
v_add_u32 v26, v26, v27
v_mfma_f32_32x32x16_bf16 v[88:103], v[52:55], v[44:47], v[136:151]
ds_read_b128 v[48:51], v25 offset:2048
ds_read_b64_tr_b16 v[64:65], v26 offset:0
ds_read_b64_tr_b16 v[66:67], v26 offset:256
ds_read_b64_tr_b16 v[68:69], v26 offset:512
ds_read_b64_tr_b16 v[70:71], v26 offset:768
v_exp_f32 v72, v72
v_exp_f32 v73, v73
v_exp_f32 v74, v74
v_exp_f32 v75, v75
v_exp_f32 v76, v76
v_exp_f32 v77, v77
v_exp_f32 v78, v78
v_exp_f32 v79, v79
s_nop 0
v_cvt_pk_bf16_f32 v104, v72, v73
v_cvt_pk_bf16_f32 v105, v74, v75
v_cvt_pk_bf16_f32 v106, v76, v77
v_cvt_pk_bf16_f32 v107, v78, v79
v_exp_f32 v80, v80
v_exp_f32 v81, v81
v_exp_f32 v82, v82
v_exp_f32 v83, v83
v_mfma_f32_32x32x16_bf16 v[112:127], v[56:59], v[104:107], v[112:127]
v_exp_f32 v84, v84
v_exp_f32 v85, v85
v_exp_f32 v86, v86
v_exp_f32 v87, v87
v_cvt_pk_bf16_f32 v108, v80, v81
v_cvt_pk_bf16_f32 v109, v82, v83
v_cvt_pk_bf16_f32 v110, v84, v85
v_cvt_pk_bf16_f32 v111, v86, v87
s_waitcnt vmcnt(2)
s_barrier
v_add_u32 v34, 49152, v23
v_add_u32 v35, 98304, v23
s_waitcnt lgkmcnt(0)
s_cmp_eq_u32 s75, 5
s_cbranch_scc1 Lmsk_11
Lmsk_11r:
v_mfma_f32_32x32x16_bf16 v[112:127], v[60:63], v[108:111], v[112:127]
v_add_u32 v26, v26, v27
v_mfma_f32_32x32x16_bf16 v[72:87], v[48:51], v[44:47], v[136:151]
ds_read_b128 v[52:55], v25 offset:1024
ds_read_b64_tr_b16 v[56:57], v26 offset:0
ds_read_b64_tr_b16 v[58:59], v26 offset:256
ds_read_b64_tr_b16 v[60:61], v26 offset:512
ds_read_b64_tr_b16 v[62:63], v26 offset:768
v_exp_f32 v88, v88
v_exp_f32 v89, v89
v_exp_f32 v90, v90
v_exp_f32 v91, v91
v_exp_f32 v92, v92
v_exp_f32 v93, v93
v_exp_f32 v94, v94
v_exp_f32 v95, v95
s_nop 0
ds_read_b64_tr_b16 v[208:209], v34 offset:0
ds_read_b64_tr_b16 v[210:211], v34 offset:1024
ds_read_b64_tr_b16 v[212:213], v34 offset:2048
ds_read_b64_tr_b16 v[214:215], v34 offset:3072
ds_read_b64_tr_b16 v[216:217], v34 offset:4096
ds_read_b64_tr_b16 v[218:219], v34 offset:5120
ds_read_b64_tr_b16 v[220:221], v34 offset:6144
v_cvt_pk_bf16_f32 v104, v88, v89
v_cvt_pk_bf16_f32 v105, v90, v91
v_cvt_pk_bf16_f32 v106, v92, v93
v_cvt_pk_bf16_f32 v107, v94, v95
v_exp_f32 v96, v96
v_exp_f32 v97, v97
v_exp_f32 v98, v98
v_exp_f32 v99, v99
v_mfma_f32_32x32x16_bf16 v[112:127], v[64:67], v[104:107], v[112:127]
ds_read_b64_tr_b16 v[222:223], v34 offset:7168
ds_read_b64_tr_b16 v[224:225], v34 offset:8192
ds_read_b64_tr_b16 v[226:227], v34 offset:9216
ds_read_b64_tr_b16 v[228:229], v34 offset:10240
ds_read_b64_tr_b16 v[230:231], v34 offset:11264
ds_read_b64_tr_b16 v[232:233], v35 offset:0
ds_read_b64_tr_b16 v[234:235], v35 offset:1024
v_exp_f32 v100, v100
v_exp_f32 v101, v101
v_exp_f32 v102, v102
v_exp_f32 v103, v103
ds_read_b64_tr_b16 v[236:237], v35 offset:2048
ds_read_b64_tr_b16 v[238:239], v35 offset:3072
ds_read_b64_tr_b16 v[240:241], v35 offset:4096
ds_read_b64_tr_b16 v[242:243], v35 offset:5120
ds_read_b64_tr_b16 v[244:245], v35 offset:6144
ds_read_b64_tr_b16 v[246:247], v35 offset:7168
v_cvt_pk_bf16_f32 v108, v96, v97
v_cvt_pk_bf16_f32 v109, v98, v99
v_cvt_pk_bf16_f32 v110, v100, v101
v_cvt_pk_bf16_f32 v111, v102, v103
s_waitcnt lgkmcnt(0)
s_barrier
s_mov_b32 s56, s26
s_and_b32 s57, s27, 0xffff
s_mov_b32 s58, 1024
s_mov_b32 s59, 0x20000
v_and_b32 v7, 7, v0
v_lshlrev_b32 v7, 4, v7
s_lshl_b32 s82, s72, 7
buffer_load_dwordx2 v[32:33], v21, s[44:47], 0 offen sc1
s_waitcnt lgkmcnt(15)
s_cmp_eq_u32 s75, 6
s_cbranch_scc1 Lmsk_12
Lmsk_12r:
v_mfma_f32_32x32x16_bf16 v[112:127], v[68:71], v[108:111], v[112:127]
v_add_u32 v26, v26, v27
v_mfma_f32_32x32x16_bf16 v[88:103], v[52:55], v[44:47], v[136:151]
ds_read_b128 v[48:51], v25 offset:0
ds_read_b64_tr_b16 v[64:65], v26 offset:0
ds_read_b64_tr_b16 v[66:67], v26 offset:256
ds_read_b64_tr_b16 v[68:69], v26 offset:512
ds_read_b64_tr_b16 v[70:71], v26 offset:768
v_exp_f32 v72, v72
v_exp_f32 v73, v73
v_exp_f32 v74, v74
v_exp_f32 v75, v75
v_exp_f32 v76, v76
v_exp_f32 v77, v77
v_exp_f32 v78, v78
v_exp_f32 v79, v79
s_add_u32 m0, s94, 98304
s_add_u32 s93, s93, 16384
s_and_b32 s93, s93, 0x1ffff
s_lshl_b32 s89, s73, 17
s_or_b32 s89, s89, s93
buffer_load_dwordx4 v2, s[40:43], s89 offen lds
v_cvt_pk_bf16_f32 v104, v72, v73
v_cvt_pk_bf16_f32 v105, v74, v75
v_cvt_pk_bf16_f32 v106, v76, v77
v_cvt_pk_bf16_f32 v107, v78, v79
v_exp_f32 v80, v80
v_exp_f32 v81, v81
v_exp_f32 v82, v82
v_exp_f32 v83, v83
v_mfma_f32_32x32x16_bf16 v[112:127], v[56:59], v[104:107], v[112:127]
s_add_u32 m0, s94, 100352
s_add_u32 s93, s93, 16384
s_and_b32 s93, s93, 0x1ffff
s_lshl_b32 s89, s73, 17
s_or_b32 s89, s89, s93
buffer_load_dwordx4 v2, s[40:43], s89 offen lds
v_exp_f32 v84, v84
v_exp_f32 v85, v85
v_exp_f32 v86, v86
v_exp_f32 v87, v87
s_add_u32 m0, s94, 102400
s_add_u32 s93, s93, 16384
s_and_b32 s93, s93, 0x1ffff
s_lshl_b32 s89, s73, 17
s_or_b32 s89, s89, s93
buffer_load_dwordx4 v2, s[40:43], s89 offen lds
v_cvt_pk_bf16_f32 v108, v80, v81
v_cvt_pk_bf16_f32 v109, v82, v83
v_cvt_pk_bf16_f32 v110, v84, v85
v_cvt_pk_bf16_f32 v111, v86, v87
s_waitcnt vmcnt(3)
v_cmp_ne_u64 vcc, s[84:85], v[32:33]
s_mov_b32 s12, s95
s_cmp_eq_u64 vcc, 0
s_cselect_b64 s[22:23], -1, 0
s_cselect_b32 s5, 1, 0
s_waitcnt lgkmcnt(0)
s_nop 0
v_mfma_f32_32x32x16_bf16 v[112:127], v[60:63], v[108:111], v[112:127]
v_add_u32 v26, v26, v27
ds_read_b128 v[72:75], v28 offset:4096
ds_read_b128 v[76:79], v28 offset:5120
ds_read_b128 v[80:83], v28 offset:6144
ds_read_b128 v[84:87], v28 offset:7168
ds_read_b64_tr_b16 v[56:57], v26 offset:0
ds_read_b64_tr_b16 v[58:59], v26 offset:256
ds_read_b64_tr_b16 v[60:61], v26 offset:512
ds_read_b64_tr_b16 v[62:63], v26 offset:768
v_exp_f32 v88, v88
v_exp_f32 v89, v89
v_exp_f32 v90, v90
v_exp_f32 v91, v91
v_exp_f32 v92, v92
v_exp_f32 v93, v93
v_exp_f32 v94, v94
v_exp_f32 v95, v95
s_waitcnt lgkmcnt(4)
s_cmp_le_u32 s75, 7
s_cbranch_scc1 Lmsk_13
Lmsk_13r:
v_mfma_f32_32x32x16_bf16 v[72:87], v[48:51], v[44:47], v[72:87]
v_cvt_pk_bf16_f32 v104, v88, v89
v_cvt_pk_bf16_f32 v105, v90, v91
v_cvt_pk_bf16_f32 v106, v92, v93
v_cvt_pk_bf16_f32 v107, v94, v95
v_exp_f32 v96, v96
v_exp_f32 v97, v97
v_exp_f32 v98, v98
v_exp_f32 v99, v99
v_mfma_f32_32x32x16_bf16 v[112:127], v[64:67], v[104:107], v[112:127]
s_add_u32 m0, s21, 65536
s_nop 0
s_mov_b64 exec, s[22:23]
buffer_load_dwordx4 v1, s[44:47], s95 offen sc1 lds
s_mov_b64 exec, -1
v_exp_f32 v100, v100
v_exp_f32 v101, v101
v_exp_f32 v102, v102
v_exp_f32 v103, v103
s_add_u32 m0, s21, 66560
s_add_u32 s95, s95, 1024
s_cmp_eq_u32 s95, s101
s_cselect_b32 s95, s100, s95
s_mov_b64 exec, s[22:23]
buffer_load_dwordx4 v1, s[44:47], s95 offen sc1 lds
s_mov_b64 exec, -1
v_cvt_pk_bf16_f32 v108, v96, v97
v_cvt_pk_bf16_f32 v109, v98, v99
v_cvt_pk_bf16_f32 v110, v100, v101
v_cvt_pk_bf16_f32 v111, v102, v103
s_waitcnt lgkmcnt(0)
s_nop 0
v_mfma_f32_32x32x16_bf16 v[112:127], v[68:71], v[108:111], v[112:127]
v_exp_f32 v72, v72
v_exp_f32 v73, v73
v_exp_f32 v74, v74
v_exp_f32 v75, v75
v_exp_f32 v76, v76
v_exp_f32 v77, v77
v_exp_f32 v78, v78
v_exp_f32 v79, v79
s_add_u32 m0, s21, 67584
s_add_u32 s95, s95, 1024
s_cmp_eq_u32 s95, s101
s_cselect_b32 s95, s100, s95
s_mov_b64 exec, s[22:23]
buffer_load_dwordx4 v1, s[44:47], s95 offen sc1 lds
s_mov_b64 exec, -1
v_cvt_pk_bf16_f32 v104, v72, v73
v_cvt_pk_bf16_f32 v105, v74, v75
v_cvt_pk_bf16_f32 v106, v76, v77
v_cvt_pk_bf16_f32 v107, v78, v79
v_exp_f32 v80, v80
v_exp_f32 v81, v81
v_exp_f32 v82, v82
v_exp_f32 v83, v83
v_mfma_f32_32x32x16_bf16 v[112:127], v[56:59], v[104:107], v[112:127]
s_add_u32 m0, s21, 68608
s_add_u32 s95, s95, 1024
s_cmp_eq_u32 s95, s101
s_cselect_b32 s95, s100, s95
s_mov_b64 exec, s[22:23]
buffer_load_dwordx4 v1, s[44:47], s95 offen sc1 lds
s_mov_b64 exec, -1
v_exp_f32 v84, v84
v_exp_f32 v85, v85
v_exp_f32 v86, v86
v_exp_f32 v87, v87
s_add_u32 m0, s94, 104448
s_add_u32 s93, s93, 16384
s_and_b32 s93, s93, 0x1ffff
s_lshl_b32 s89, s73, 17
s_or_b32 s89, s89, s93
buffer_load_dwordx4 v2, s[40:43], s89 offen lds
v_cvt_pk_bf16_f32 v108, v80, v81
v_cvt_pk_bf16_f32 v109, v82, v83
v_cvt_pk_bf16_f32 v110, v84, v85
v_cvt_pk_bf16_f32 v111, v86, v87
s_nop 0
s_waitcnt lgkmcnt(0)
v_mfma_f32_32x32x16_bf16 v[112:127], v[60:63], v[108:111], v[112:127]
buffer_load_dwordx4 v[152:155], v13, s[28:31], s18 offen
buffer_load_dwordx4 v[156:159], v7, s[56:59], s82 offen
s_mov_b32 s86, 0x1f800000
s_mov_b32 s83, 0x5f800000
s_nop 9
v_cmp_le_f32 vcc, s86, v120
v_cmp_ge_f32 s[10:11], s83, v120
s_and_b64 vcc, vcc, s[10:11]
s_cmp_eq_u64 vcc, -1
s_cbranch_scc0 L_fallback
L_attfin:
v_rcp_f32 v6, v120
s_nop 0
v_pk_mul_f32 v[112:113], v[112:113], v[6:7] op_sel:[0,0] op_sel_hi:[1,0]
v_pk_mul_f32 v[114:115], v[114:115], v[6:7] op_sel:[0,0] op_sel_hi:[1,0]
v_pk_mul_f32 v[116:117], v[116:117], v[6:7] op_sel:[0,0] op_sel_hi:[1,0]
v_pk_mul_f32 v[118:119], v[118:119], v[6:7] op_sel:[0,0] op_sel_hi:[1,0]
v_cvt_pk_bf16_f32 v104, v112, v113
v_cvt_pk_bf16_f32 v105, v114, v115
v_cvt_pk_bf16_f32 v106, v116, v117
v_cvt_pk_bf16_f32 v107, v118, v119
buffer_store_dwordx4 v[104:107], v1, s[44:47], s19 offen sc1
s_barrier
s_cmp_eq_u32 s5, 0
s_cbranch_scc1 L_late
L_late_ret:
s_add_u32 m0, s21, 0
s_add_u32 s95, s95, 1024
s_cmp_eq_u32 s95, s101
s_cselect_b32 s95, s100, s95
buffer_load_dwordx4 v1, s[44:47], s95 offen sc1 lds
s_add_u32 m0, s21, 1024
s_add_u32 s95, s95, 1024
s_cmp_eq_u32 s95, s101
s_cselect_b32 s95, s100, s95
buffer_load_dwordx4 v1, s[44:47], s95 offen sc1 lds
s_add_u32 m0, s21, 2048
s_add_u32 s95, s95, 1024
s_cmp_eq_u32 s95, s101
s_cselect_b32 s95, s100, s95
buffer_load_dwordx4 v1, s[44:47], s95 offen sc1 lds
s_add_u32 m0, s21, 3072
s_add_u32 s95, s95, 1024
s_cmp_eq_u32 s95, s101
s_cselect_b32 s95, s100, s95
buffer_load_dwordx4 v1, s[44:47], s95 offen sc1 lds
s_waitcnt vmcnt(8)
s_barrier
ds_read_b128 v[72:75], v30 offset:0
ds_read_b128 v[76:79], v30 offset:4096
ds_read_b128 v[80:83], v30 offset:1024
ds_read_b128 v[84:87], v30 offset:5120
s_lshl_b32 s86, s73, 13
s_sub_u32 s87, s94, s86
s_waitcnt lgkmcnt(2)
v_mfma_f32_32x32x16_bf16 v[96:111], v[72:75], v[160:163], 0
v_mfma_f32_32x32x16_bf16 v[112:127], v[76:79], v[160:163], 0
ds_read_b128 v[88:91], v30 offset:2048
ds_read_b128 v[92:95], v30 offset:6144
s_add_u32 m0, s21, 32768
s_add_u32 s95, s95, 1024
s_cmp_eq_u32 s95, s101
s_cselect_b32 s95, s100, s95
buffer_load_dwordx4 v1, s[44:47], s95 offen sc1 lds
s_add_u32 m0, s21, 33792
s_add_u32 s95, s95, 1024
s_cmp_eq_u32 s95, s101
s_cselect_b32 s95, s100, s95
buffer_load_dwordx4 v1, s[44:47], s95 offen sc1 lds
s_waitcnt lgkmcnt(2)
v_mfma_f32_32x32x16_bf16 v[96:111], v[80:83], v[164:167], v[96:111]
v_mfma_f32_32x32x16_bf16 v[112:127], v[84:87], v[164:167], v[112:127]
ds_read_b128 v[72:75], v30 offset:3072
ds_read_b128 v[76:79], v30 offset:7168
s_add_u32 m0, s21, 34816
s_add_u32 s95, s95, 1024
s_cmp_eq_u32 s95, s101
s_cselect_b32 s95, s100, s95
buffer_load_dwordx4 v1, s[44:47], s95 offen sc1 lds
s_add_u32 m0, s21, 35840
s_add_u32 s95, s95, 1024
s_cmp_eq_u32 s95, s101
s_cselect_b32 s95, s100, s95
buffer_load_dwordx4 v1, s[44:47], s95 offen sc1 lds
s_waitcnt lgkmcnt(0)
v_mfma_f32_32x32x16_bf16 v[96:111], v[88:91], v[168:171], v[96:111]
v_mfma_f32_32x32x16_bf16 v[112:127], v[92:95], v[168:171], v[112:127]
s_waitcnt vmcnt(4)
s_mov_b64 exec, 1
buffer_store_dwordx2 v[4:5], off, s[44:47], s81 offset:128 sc1
s_mov_b64 exec, -1
s_barrier
ds_read_b128 v[80:83], v29 offset:0
ds_read_b128 v[84:87], v29 offset:4096
s_add_u32 m0, s21, 65536
s_add_u32 s95, s95, 1024
s_cmp_eq_u32 s95, s101
s_cselect_b32 s95, s100, s95
buffer_load_dwordx4 v1, s[44:47], s95 offen sc1 lds
v_mfma_f32_32x32x16_bf16 v[96:111], v[72:75], v[172:175], v[96:111]
v_mfma_f32_32x32x16_bf16 v[112:127], v[76:79], v[172:175], v[112:127]
ds_read_b128 v[88:91], v29 offset:1024
ds_read_b128 v[92:95], v29 offset:5120
s_add_u32 m0, s21, 66560
s_add_u32 s95, s95, 1024
s_cmp_eq_u32 s95, s101
s_cselect_b32 s95, s100, s95
buffer_load_dwordx4 v1, s[44:47], s95 offen sc1 lds
s_add_u32 m0, s21, 67584
s_add_u32 s95, s95, 1024
s_cmp_eq_u32 s95, s101
s_cselect_b32 s95, s100, s95
buffer_load_dwordx4 v1, s[44:47], s95 offen sc1 lds
s_waitcnt lgkmcnt(2)
v_mfma_f32_32x32x16_bf16 v[96:111], v[80:83], v[176:179], v[96:111]
v_mfma_f32_32x32x16_bf16 v[112:127], v[84:87], v[176:179], v[112:127]
ds_read_b128 v[72:75], v29 offset:2048
ds_read_b128 v[76:79], v29 offset:6144
s_add_u32 m0, s21, 68608
s_add_u32 s95, s95, 1024
s_cmp_eq_u32 s95, s101
s_cselect_b32 s95, s100, s95
buffer_load_dwordx4 v1, s[44:47], s95 offen sc1 lds
s_waitcnt lgkmcnt(2)
v_mfma_f32_32x32x16_bf16 v[96:111], v[88:91], v[180:183], v[96:111]
v_mfma_f32_32x32x16_bf16 v[112:127], v[92:95], v[180:183], v[112:127]
ds_read_b128 v[80:83], v29 offset:3072
ds_read_b128 v[84:87], v29 offset:7168
s_add_u32 m0, s87, 147456
s_add_u32 s93, s93, 16384
s_and_b32 s93, s93, 0x1ffff
s_lshl_b32 s89, s73, 17
s_or_b32 s89, s89, s93
buffer_load_dwordx4 v2, s[40:43], s89 offen lds
s_add_u32 m0, s87, 149504
s_add_u32 s93, s93, 16384
s_and_b32 s93, s93, 0x1ffff
s_lshl_b32 s89, s73, 17
s_or_b32 s89, s89, s93
buffer_load_dwordx4 v2, s[40:43], s89 offen lds
s_waitcnt lgkmcnt(0)
v_mfma_f32_32x32x16_bf16 v[96:111], v[72:75], v[184:187], v[96:111]
v_mfma_f32_32x32x16_bf16 v[112:127], v[76:79], v[184:187], v[112:127]
s_waitcnt vmcnt(7)
s_barrier
ds_read_b128 v[88:91], v29 offset:32768
ds_read_b128 v[92:95], v29 offset:36864
s_add_u32 m0, s21, 0
s_add_u32 s95, s95, 1024
s_cmp_eq_u32 s95, s101
s_cselect_b32 s95, s100, s95
buffer_load_dwordx4 v1, s[44:47], s95 offen sc1 lds
v_add_u32 v34, 106496, v24
v_add_u32 v35, 98304, v24
v_mfma_f32_32x32x16_bf16 v[96:111], v[80:83], v[188:191], v[96:111]
v_mfma_f32_32x32x16_bf16 v[112:127], v[84:87], v[188:191], v[112:127]
ds_read_b128 v[72:75], v29 offset:33792
ds_read_b128 v[76:79], v29 offset:37888
ds_read_b64_tr_b16 v[248:249], v34 offset:0
ds_read_b64_tr_b16 v[250:251], v34 offset:512
ds_read_b64_tr_b16 v[252:253], v34 offset:2048
ds_read_b64_tr_b16 v[254:255], v34 offset:2560
s_add_u32 m0, s21, 1024
s_add_u32 s95, s95, 1024
s_cmp_eq_u32 s95, s101
s_cselect_b32 s95, s100, s95
buffer_load_dwordx4 v1, s[44:47], s95 offen sc1 lds
s_waitcnt lgkmcnt(6)
v_mfma_f32_32x32x16_bf16 v[96:111], v[88:91], v[192:195], v[96:111]
v_mfma_f32_32x32x16_bf16 v[112:127], v[92:95], v[192:195], v[112:127]
ds_read_b128 v[80:83], v29 offset:34816
ds_read_b128 v[84:87], v29 offset:38912
ds_read_b64_tr_b16 v[128:129], v35 offset:0
ds_read_b64_tr_b16 v[130:131], v35 offset:512
ds_read_b64_tr_b16 v[132:133], v35 offset:2048
ds_read_b64_tr_b16 v[134:135], v35 offset:2560
s_add_u32 m0, s21, 2048
s_add_u32 s95, s95, 1024
s_cmp_eq_u32 s95, s101
s_cselect_b32 s95, s100, s95
buffer_load_dwordx4 v1, s[44:47], s95 offen sc1 lds
s_waitcnt lgkmcnt(10)
v_mfma_f32_32x32x16_bf16 v[96:111], v[72:75], v[196:199], v[96:111]
v_mfma_f32_32x32x16_bf16 v[112:127], v[76:79], v[196:199], v[112:127]
ds_read_b128 v[88:91], v29 offset:35840
ds_read_b128 v[92:95], v29 offset:39936
ds_read_b64_tr_b16 v[136:137], v35 offset:4096
ds_read_b64_tr_b16 v[138:139], v35 offset:4608
ds_read_b64_tr_b16 v[140:141], v35 offset:6144
ds_read_b64_tr_b16 v[142:143], v35 offset:6656
s_add_u32 m0, s21, 3072
s_add_u32 s95, s95, 1024
s_cmp_eq_u32 s95, s101
s_cselect_b32 s95, s100, s95
buffer_load_dwordx4 v1, s[44:47], s95 offen sc1 lds
s_waitcnt lgkmcnt(0)
v_mfma_f32_32x32x16_bf16 v[96:111], v[80:83], v[200:203], v[96:111]
v_mfma_f32_32x32x16_bf16 v[112:127], v[84:87], v[200:203], v[112:127]
s_waitcnt vmcnt(6)
s_barrier
ds_read_b128 v[72:75], v30 offset:0
ds_read_b128 v[76:79], v30 offset:4096
s_add_u32 m0, s21, 32768
s_add_u32 s95, s95, 1024
s_cmp_eq_u32 s95, s101
s_cselect_b32 s95, s100, s95
buffer_load_dwordx4 v1, s[44:47], s95 offen sc1 lds
v_lshlrev_b32 v36, 16, v152
v_and_b32 v37, 0xffff0000, v152
v_lshlrev_b32 v152, 16, v156
v_and_b32 v156, 0xffff0000, v156
v_add_f32 v36, v36, v152
v_add_f32 v37, v37, v156
v_lshlrev_b32 v38, 16, v153
v_and_b32 v39, 0xffff0000, v153
v_lshlrev_b32 v153, 16, v157
v_and_b32 v157, 0xffff0000, v157
v_add_f32 v38, v38, v153
v_add_f32 v39, v39, v157
v_lshlrev_b32 v40, 16, v154
v_and_b32 v41, 0xffff0000, v154
v_lshlrev_b32 v154, 16, v158
v_and_b32 v158, 0xffff0000, v158
v_add_f32 v40, v40, v154
v_add_f32 v41, v41, v158
v_lshlrev_b32 v42, 16, v155
v_and_b32 v43, 0xffff0000, v155
v_lshlrev_b32 v155, 16, v159
v_and_b32 v159, 0xffff0000, v159
v_add_f32 v42, v42, v155
v_add_f32 v43, v43, v159
v_mfma_f32_32x32x16_bf16 v[96:111], v[88:91], v[204:207], v[96:111]
v_mfma_f32_32x32x16_bf16 v[112:127], v[92:95], v[204:207], v[112:127]
ds_read_b128 v[80:83], v30 offset:1024
ds_read_b128 v[84:87], v30 offset:5120
s_add_u32 m0, s21, 33792
s_add_u32 s95, s95, 1024
s_cmp_eq_u32 s95, s101
s_cselect_b32 s95, s100, s95
buffer_load_dwordx4 v1, s[44:47], s95 offen sc1 lds
s_waitcnt lgkmcnt(2)
v_mfma_f32_32x32x16_bf16 v[96:111], v[72:75], v[208:211], v[96:111]
v_mfma_f32_32x32x16_bf16 v[112:127], v[76:79], v[208:211], v[112:127]
ds_read_b128 v[88:91], v30 offset:2048
ds_read_b128 v[92:95], v30 offset:6144
buffer_load_dwordx2 v[32:33], v22, s[44:47], 0 offen sc1
s_waitcnt lgkmcnt(2)
v_mfma_f32_32x32x16_bf16 v[96:111], v[80:83], v[212:215], v[96:111]
v_mfma_f32_32x32x16_bf16 v[112:127], v[84:87], v[212:215], v[112:127]
ds_read_b128 v[72:75], v30 offset:3072
ds_read_b128 v[76:79], v30 offset:7168
s_waitcnt lgkmcnt(0)
v_mfma_f32_32x32x16_bf16 v[96:111], v[88:91], v[216:219], v[96:111]
v_mfma_f32_32x32x16_bf16 v[112:127], v[92:95], v[216:219], v[112:127]
s_waitcnt vmcnt(3)
s_barrier
ds_read_b128 v[80:83], v29 offset:0
ds_read_b128 v[84:87], v29 offset:4096
s_waitcnt vmcnt(0)
v_cmp_ne_u64 vcc, s[84:85], v[32:33]
s_cbranch_vccnz Lsp_14
Lspe_15:
s_add_u32 m0, s21, 65536
s_add_u32 s89, s16, s17
buffer_load_dwordx4 v1, s[44:47], s89 offen sc1 lds
v_add_u32 v6, 147456, v24
v_subrev_u32 v6, s86, v6
ds_read_b64_tr_b16 v[144:145], v6 offset:0
ds_read_b64_tr_b16 v[146:147], v6 offset:512
ds_read_b64_tr_b16 v[148:149], v6 offset:2048
ds_read_b64_tr_b16 v[150:151], v6 offset:2560
v_mfma_f32_32x32x16_bf16 v[96:111], v[72:75], v[220:223], v[96:111]
v_mfma_f32_32x32x16_bf16 v[112:127], v[76:79], v[220:223], v[112:127]
ds_read_b128 v[88:91], v29 offset:1024
ds_read_b128 v[92:95], v29 offset:5120
s_add_u32 m0, s21, 66560
s_add_u32 s16, s16, 1024
s_and_b32 s16, s16, 0x1fff
s_add_u32 s89, s16, s17
buffer_load_dwordx4 v1, s[44:47], s89 offen sc1 lds
s_waitcnt lgkmcnt(6)
v_mfma_f32_32x32x16_bf16 v[96:111], v[80:83], v[224:227], v[96:111]
v_mfma_f32_32x32x16_bf16 v[112:127], v[84:87], v[224:227], v[112:127]
ds_read_b128 v[72:75], v29 offset:2048
ds_read_b128 v[76:79], v29 offset:6144
s_add_u32 m0, s21, 67584
s_add_u32 s16, s16, 1024
s_and_b32 s16, s16, 0x1fff
s_add_u32 s89, s16, s17
buffer_load_dwordx4 v1, s[44:47], s89 offen sc1 lds
s_waitcnt lgkmcnt(2)
v_mfma_f32_32x32x16_bf16 v[96:111], v[88:91], v[228:231], v[96:111]
v_mfma_f32_32x32x16_bf16 v[112:127], v[92:95], v[228:231], v[112:127]
ds_read_b128 v[80:83], v29 offset:3072
ds_read_b128 v[84:87], v29 offset:7168
s_add_u32 m0, s21, 68608
s_add_u32 s16, s16, 1024
s_and_b32 s16, s16, 0x1fff
s_add_u32 s89, s16, s17
buffer_load_dwordx4 v1, s[44:47], s89 offen sc1 lds
s_waitcnt lgkmcnt(0)
v_mfma_f32_32x32x16_bf16 v[96:111], v[72:75], v[232:235], v[96:111]
v_mfma_f32_32x32x16_bf16 v[112:127], v[76:79], v[232:235], v[112:127]
s_waitcnt vmcnt(5)
s_barrier
ds_read_b128 v[88:91], v29 offset:32768
ds_read_b128 v[92:95], v29 offset:36864
s_add_u32 m0, s21, 0
s_add_u32 s16, s16, 1024
s_and_b32 s16, s16, 0x1fff
s_add_u32 s89, s16, s17
buffer_load_dwordx4 v1, s[44:47], s89 offen sc1 lds
v_mfma_f32_32x32x16_bf16 v[96:111], v[80:83], v[236:239], v[96:111]
v_mfma_f32_32x32x16_bf16 v[112:127], v[84:87], v[236:239], v[112:127]
ds_read_b128 v[72:75], v29 offset:33792
ds_read_b128 v[76:79], v29 offset:37888
s_add_u32 m0, s21, 1024
s_add_u32 s16, s16, 1024
s_and_b32 s16, s16, 0x1fff
s_add_u32 s89, s16, s17
buffer_load_dwordx4 v1, s[44:47], s89 offen sc1 lds
s_add_u32 m0, s21, 2048
s_add_u32 s16, s16, 1024
s_and_b32 s16, s16, 0x1fff
s_add_u32 s89, s16, s17
buffer_load_dwordx4 v1, s[44:47], s89 offen sc1 lds
s_add_u32 m0, s21, 3072
s_add_u32 s16, s16, 1024
s_and_b32 s16, s16, 0x1fff
s_add_u32 s89, s16, s17
buffer_load_dwordx4 v1, s[44:47], s89 offen sc1 lds
s_waitcnt lgkmcnt(0)
v_mfma_f32_32x32x16_bf16 v[96:111], v[88:91], v[240:243], v[96:111]
v_mfma_f32_32x32x16_bf16 v[112:127], v[92:95], v[240:243], v[112:127]
s_waitcnt vmcnt(4)
s_barrier
ds_read_b128 v[80:83], v30 offset:0
ds_read_b128 v[84:87], v30 offset:4096
s_cmp_ge_u32 s73, 2
s_cbranch_scc1 Lk21_16
v_mfma_f32_32x32x16_bf16 v[96:111], v[72:75], v[244:247], v[96:111]
v_mfma_f32_32x32x16_bf16 v[112:127], v[76:79], v[244:247], v[112:127]
Lk21_16:
ds_read_b128 v[88:91], v30 offset:1024
ds_read_b128 v[92:95], v30 offset:5120
s_waitcnt lgkmcnt(2)
v_mfma_f32_32x32x16_bf16 v[96:111], v[80:83], v[248:251], v[96:111]
v_mfma_f32_32x32x16_bf16 v[112:127], v[84:87], v[248:251], v[112:127]
ds_read_b128 v[72:75], v30 offset:2048
ds_read_b128 v[76:79], v30 offset:6144
s_waitcnt lgkmcnt(2)
v_mfma_f32_32x32x16_bf16 v[96:111], v[88:91], v[252:255], v[96:111]
v_mfma_f32_32x32x16_bf16 v[112:127], v[92:95], v[252:255], v[112:127]
ds_read_b128 v[80:83], v30 offset:3072
ds_read_b128 v[84:87], v30 offset:7168
s_waitcnt lgkmcnt(0)
v_mfma_f32_32x32x16_bf16 v[96:111], v[72:75], v[128:131], v[96:111]
v_mfma_f32_32x32x16_bf16 v[112:127], v[76:79], v[128:131], v[112:127]
s_waitcnt vmcnt(0)
s_barrier
ds_read_b128 v[88:91], v29 offset:0
ds_read_b128 v[92:95], v29 offset:4096
v_mfma_f32_32x32x16_bf16 v[96:111], v[80:83], v[132:135], v[96:111]
v_mfma_f32_32x32x16_bf16 v[112:127], v[84:87], v[132:135], v[112:127]
ds_read_b128 v[72:75], v29 offset:1024
ds_read_b128 v[76:79], v29 offset:5120
s_waitcnt lgkmcnt(2)
v_mfma_f32_32x32x16_bf16 v[96:111], v[88:91], v[136:139], v[96:111]
v_mfma_f32_32x32x16_bf16 v[112:127], v[92:95], v[136:139], v[112:127]
ds_read_b128 v[80:83], v29 offset:2048
ds_read_b128 v[84:87], v29 offset:6144
s_waitcnt lgkmcnt(2)
v_mfma_f32_32x32x16_bf16 v[96:111], v[72:75], v[140:143], v[96:111]
v_mfma_f32_32x32x16_bf16 v[112:127], v[76:79], v[140:143], v[112:127]
ds_read_b128 v[88:91], v29 offset:3072
ds_read_b128 v[92:95], v29 offset:7168
s_waitcnt lgkmcnt(0)
v_mfma_f32_32x32x16_bf16 v[96:111], v[80:83], v[144:147], v[96:111]
v_mfma_f32_32x32x16_bf16 v[112:127], v[84:87], v[144:147], v[112:127]
s_barrier
v_mfma_f32_32x32x16_bf16 v[96:111], v[88:91], v[148:151], v[96:111]
v_mfma_f32_32x32x16_bf16 v[112:127], v[92:95], v[148:151], v[112:127]
s_mul_i32 s82, s64, 8704
s_mov_b32 m0, s82
s_nop 8
ds_write_addtid_b32 v96 offset:0
ds_write_addtid_b32 v97 offset:272
ds_write_addtid_b32 v98 offset:544
ds_write_addtid_b32 v99 offset:816
ds_write_addtid_b32 v100 offset:1088
ds_write_addtid_b32 v101 offset:1360
ds_write_addtid_b32 v102 offset:1632
ds_write_addtid_b32 v103 offset:1904
ds_write_addtid_b32 v104 offset:2176
ds_write_addtid_b32 v105 offset:2448
ds_write_addtid_b32 v106 offset:2720
ds_write_addtid_b32 v107 offset:2992
ds_write_addtid_b32 v108 offset:3264
ds_write_addtid_b32 v109 offset:3536
ds_write_addtid_b32 v110 offset:3808
ds_write_addtid_b32 v111 offset:4080
ds_write_addtid_b32 v112 offset:4352
ds_write_addtid_b32 v113 offset:4624
ds_write_addtid_b32 v114 offset:4896
ds_write_addtid_b32 v115 offset:5168
ds_write_addtid_b32 v116 offset:5440
ds_write_addtid_b32 v117 offset:5712
ds_write_addtid_b32 v118 offset:5984
ds_write_addtid_b32 v119 offset:6256
ds_write_addtid_b32 v120 offset:6528
ds_write_addtid_b32 v121 offset:6800
ds_write_addtid_b32 v122 offset:7072
ds_write_addtid_b32 v123 offset:7344
ds_write_addtid_b32 v124 offset:7616
ds_write_addtid_b32 v125 offset:7888
ds_write_addtid_b32 v126 offset:8160
ds_write_addtid_b32 v127 offset:8432
s_waitcnt lgkmcnt(0)
s_barrier
ds_read_b128 v[160:163], v14 offset:0
ds_read_b128 v[164:167], v14 offset:16
ds_read_b128 v[168:171], v14 offset:17408
ds_read_b128 v[172:175], v14 offset:17424
ds_read_b128 v[176:179], v14 offset:34816
ds_read_b128 v[180:183], v14 offset:34832
ds_read_b128 v[184:187], v14 offset:52224
ds_read_b128 v[188:191], v14 offset:52240
s_waitcnt lgkmcnt(6)
v_pk_add_f32 v[36:37], v[36:37], v[160:161]
v_pk_add_f32 v[38:39], v[38:39], v[162:163]
v_pk_add_f32 v[40:41], v[40:41], v[164:165]
v_pk_add_f32 v[42:43], v[42:43], v[166:167]
s_waitcnt lgkmcnt(4)
v_pk_add_f32 v[36:37], v[36:37], v[168:169]
v_pk_add_f32 v[38:39], v[38:39], v[170:171]
v_pk_add_f32 v[40:41], v[40:41], v[172:173]
v_pk_add_f32 v[42:43], v[42:43], v[174:175]
s_waitcnt lgkmcnt(2)
v_pk_add_f32 v[36:37], v[36:37], v[176:177]
v_pk_add_f32 v[38:39], v[38:39], v[178:179]
v_pk_add_f32 v[40:41], v[40:41], v[180:181]
v_pk_add_f32 v[42:43], v[42:43], v[182:183]
s_waitcnt lgkmcnt(0)
v_pk_add_f32 v[36:37], v[36:37], v[184:185]
v_pk_add_f32 v[38:39], v[38:39], v[186:187]
v_pk_add_f32 v[40:41], v[40:41], v[188:189]
v_pk_add_f32 v[42:43], v[42:43], v[190:191]
v_cvt_pk_bf16_f32 v36, v36, v37
v_cvt_pk_bf16_f32 v37, v38, v39
v_cvt_pk_bf16_f32 v38, v40, v41
v_cvt_pk_bf16_f32 v39, v42, v43
buffer_store_dwordx4 v[36:39], v13, s[48:51], s18 offen
L_end:
s_endpgm
L_nonce:
s_memrealtime s[84:85]
s_waitcnt lgkmcnt(0)
s_or_b32 s85, s85, 0x80000000
v_mov_b32 v96, s84
v_mov_b32 v97, s85
s_mov_b64 exec, 1
buffer_store_dwordx2 v[96:97], off, s[60:63], 0 sc1
s_mov_b64 exec, -1
s_branch L_nonce_ret
L_nonspin:
s_mov_b32 s76, 0
L_nonspin_l:
buffer_load_dwordx2 v[4:5], off, s[60:63], 0 sc1
s_add_u32 s76, s76, 1
s_waitcnt vmcnt(0)
v_readfirstlane_b32 s85, v5
v_readfirstlane_b32 s84, v4
s_cmp_ge_u32 s76, 0x8000
s_cbranch_scc1 L_nonspin_ret
s_cmp_eq_u32 s85, 0
s_cbranch_scc1 L_nonspin_l
s_branch L_nonspin_ret
Lgs_1:
s_mov_b32 s76, 0
Lgs_1l:
buffer_load_dwordx4 v[64:67], v70, s[44:47], 0 offen sc1
s_add_u32 s76, s76, 1
s_waitcnt vmcnt(0)
v_cmp_ne_u64 vcc, s[84:85], v[66:67]
s_cmp_ge_u32 s76, 0x8000
s_cbranch_scc1 Lgs_1r
s_cbranch_vccnz Lgs_1l
s_branch Lgs_1r
Lsp_2:
s_mov_b32 s76, 0
Lsp_2l:
buffer_load_dwordx2 v[64:65], v20, s[44:47], 0 offen sc1
s_add_u32 s76, s76, 1
s_waitcnt vmcnt(0)
v_cmp_ne_u64 vcc, s[84:85], v[64:65]
s_cmp_ge_u32 s76, 0x8000
s_cbranch_scc1 Lspe_3
s_cbranch_vccnz Lsp_2l
s_branch Lspe_3
Lsp_2001:
s_mov_b32 s76, 0
Lsp_2001l:
buffer_load_dwordx2 v[32:33], v21, s[44:47], 0 offen sc1
s_add_u32 s76, s76, 1
s_waitcnt vmcnt(0)
v_cmp_ne_u64 vcc, s[84:85], v[32:33]
s_cmp_ge_u32 s76, 0x8000
s_cbranch_scc1 Lspe_2002
s_cbranch_vccnz Lsp_2001l
s_branch Lspe_2002
Lsp_14:
s_mov_b32 s76, 0
Lsp_14l:
buffer_load_dwordx2 v[32:33], v22, s[44:47], 0 offen sc1
s_add_u32 s76, s76, 1
s_waitcnt vmcnt(0)
v_cmp_ne_u64 vcc, s[84:85], v[32:33]
s_cmp_ge_u32 s76, 0x8000
s_cbranch_scc1 Lspe_15
s_cbranch_vccnz Lsp_14l
s_branch Lspe_15
Lmsk_6:
s_nop 7
v_mov_b32 v136, 0xf149f2ca
v_mov_b32 v137, 0xf149f2ca
v_mov_b32 v138, 0xf149f2ca
v_mov_b32 v139, 0xf149f2ca
v_mov_b32 v140, 0xf149f2ca
v_mov_b32 v141, 0xf149f2ca
v_mov_b32 v142, 0xf149f2ca
v_mov_b32 v143, 0xf149f2ca
v_mov_b32 v144, 0xf149f2ca
v_mov_b32 v145, 0xf149f2ca
v_mov_b32 v146, 0xf149f2ca
v_mov_b32 v147, 0xf149f2ca
v_mov_b32 v148, 0xf149f2ca
v_mov_b32 v149, 0xf149f2ca
v_mov_b32 v150, 0xf149f2ca
v_mov_b32 v151, 0xf149f2ca
s_nop 0
s_branch Lmsk_6r
Lmsk_7:
s_nop 7
v_mov_b32 v136, 0xf149f2ca
v_mov_b32 v137, 0xf149f2ca
v_mov_b32 v138, 0xf149f2ca
v_mov_b32 v139, 0xf149f2ca
v_mov_b32 v140, 0xf149f2ca
v_mov_b32 v141, 0xf149f2ca
v_mov_b32 v142, 0xf149f2ca
v_mov_b32 v143, 0xf149f2ca
v_mov_b32 v144, 0xf149f2ca
v_mov_b32 v145, 0xf149f2ca
v_mov_b32 v146, 0xf149f2ca
v_mov_b32 v147, 0xf149f2ca
v_mov_b32 v148, 0xf149f2ca
v_mov_b32 v149, 0xf149f2ca
v_mov_b32 v150, 0xf149f2ca
v_mov_b32 v151, 0xf149f2ca
s_nop 0
s_branch Lmsk_7r
Lmsk_8:
s_nop 7
v_mov_b32 v136, 0xf149f2ca
v_mov_b32 v137, 0xf149f2ca
v_mov_b32 v138, 0xf149f2ca
v_mov_b32 v139, 0xf149f2ca
v_mov_b32 v140, 0xf149f2ca
v_mov_b32 v141, 0xf149f2ca
v_mov_b32 v142, 0xf149f2ca
v_mov_b32 v143, 0xf149f2ca
v_mov_b32 v144, 0xf149f2ca
v_mov_b32 v145, 0xf149f2ca
v_mov_b32 v146, 0xf149f2ca
v_mov_b32 v147, 0xf149f2ca
v_mov_b32 v148, 0xf149f2ca
v_mov_b32 v149, 0xf149f2ca
v_mov_b32 v150, 0xf149f2ca
v_mov_b32 v151, 0xf149f2ca
s_nop 0
s_branch Lmsk_8r
Lmsk_9:
s_nop 7
v_mov_b32 v136, 0xf149f2ca
v_mov_b32 v137, 0xf149f2ca
v_mov_b32 v138, 0xf149f2ca
v_mov_b32 v139, 0xf149f2ca
v_mov_b32 v140, 0xf149f2ca
v_mov_b32 v141, 0xf149f2ca
v_mov_b32 v142, 0xf149f2ca
v_mov_b32 v143, 0xf149f2ca
v_mov_b32 v144, 0xf149f2ca
v_mov_b32 v145, 0xf149f2ca
v_mov_b32 v146, 0xf149f2ca
v_mov_b32 v147, 0xf149f2ca
v_mov_b32 v148, 0xf149f2ca
v_mov_b32 v149, 0xf149f2ca
v_mov_b32 v150, 0xf149f2ca
v_mov_b32 v151, 0xf149f2ca
s_nop 0
s_branch Lmsk_9r
Lmsk_10:
s_nop 7
v_mov_b32 v136, 0xf149f2ca
v_mov_b32 v137, 0xf149f2ca
v_mov_b32 v138, 0xf149f2ca
v_mov_b32 v139, 0xf149f2ca
v_mov_b32 v140, 0xf149f2ca
v_mov_b32 v141, 0xf149f2ca
v_mov_b32 v142, 0xf149f2ca
v_mov_b32 v143, 0xf149f2ca
v_mov_b32 v144, 0xf149f2ca
v_mov_b32 v145, 0xf149f2ca
v_mov_b32 v146, 0xf149f2ca
v_mov_b32 v147, 0xf149f2ca
v_mov_b32 v148, 0xf149f2ca
v_mov_b32 v149, 0xf149f2ca
v_mov_b32 v150, 0xf149f2ca
v_mov_b32 v151, 0xf149f2ca
s_nop 0
s_branch Lmsk_10r
Lmsk_11:
s_nop 7
v_mov_b32 v136, 0xf149f2ca
v_mov_b32 v137, 0xf149f2ca
v_mov_b32 v138, 0xf149f2ca
v_mov_b32 v139, 0xf149f2ca
v_mov_b32 v140, 0xf149f2ca
v_mov_b32 v141, 0xf149f2ca
v_mov_b32 v142, 0xf149f2ca
v_mov_b32 v143, 0xf149f2ca
v_mov_b32 v144, 0xf149f2ca
v_mov_b32 v145, 0xf149f2ca
v_mov_b32 v146, 0xf149f2ca
v_mov_b32 v147, 0xf149f2ca
v_mov_b32 v148, 0xf149f2ca
v_mov_b32 v149, 0xf149f2ca
v_mov_b32 v150, 0xf149f2ca
v_mov_b32 v151, 0xf149f2ca
s_nop 0
s_branch Lmsk_11r
Lmsk_12:
s_nop 7
v_mov_b32 v136, 0xf149f2ca
v_mov_b32 v137, 0xf149f2ca
v_mov_b32 v138, 0xf149f2ca
v_mov_b32 v139, 0xf149f2ca
v_mov_b32 v140, 0xf149f2ca
v_mov_b32 v141, 0xf149f2ca
v_mov_b32 v142, 0xf149f2ca
v_mov_b32 v143, 0xf149f2ca
v_mov_b32 v144, 0xf149f2ca
v_mov_b32 v145, 0xf149f2ca
v_mov_b32 v146, 0xf149f2ca
v_mov_b32 v147, 0xf149f2ca
v_mov_b32 v148, 0xf149f2ca
v_mov_b32 v149, 0xf149f2ca
v_mov_b32 v150, 0xf149f2ca
v_mov_b32 v151, 0xf149f2ca
s_nop 0
s_branch Lmsk_12r
Lmsk_13:
s_nop 7
v_mov_b32 v72, 0xf149f2ca
v_mov_b32 v73, 0xf149f2ca
v_mov_b32 v74, 0xf149f2ca
v_mov_b32 v75, 0xf149f2ca
v_mov_b32 v76, 0xf149f2ca
v_mov_b32 v77, 0xf149f2ca
v_mov_b32 v78, 0xf149f2ca
v_mov_b32 v79, 0xf149f2ca
v_mov_b32 v80, 0xf149f2ca
v_mov_b32 v81, 0xf149f2ca
v_mov_b32 v82, 0xf149f2ca
v_mov_b32 v83, 0xf149f2ca
v_mov_b32 v84, 0xf149f2ca
v_mov_b32 v85, 0xf149f2ca
v_mov_b32 v86, 0xf149f2ca
v_mov_b32 v87, 0xf149f2ca
s_nop 0
s_branch Lmsk_13r
L_fallback:
s_min_u32 s88, s75, 8
s_mov_b32 s87, 0
v_add_u32 v128, 8192, v25
v_mov_b32 v129, 0xff61b1e6
Lfa_1001:
ds_read_b128 v[48:51], v128
s_waitcnt lgkmcnt(0)
v_mfma_f32_32x32x16_bf16 v[72:87], v[48:51], v[44:47], 0
s_and_b32 s83, s87, 7
s_cmp_lg_u32 s83, 0
s_nop 15
s_cbranch_scc1 Lfb_1002
s_lshl_b32 s83, s87, 9
v_add_u32 v131, s83, v28
ds_read_b128 v[88:91], v131 offset:0
ds_read_b128 v[92:95], v131 offset:1024
ds_read_b128 v[96:99], v131 offset:2048
ds_read_b128 v[100:103], v131 offset:3072
s_waitcnt lgkmcnt(0)
v_add_f32 v72, v72, v88
v_add_f32 v73, v73, v89
v_add_f32 v74, v74, v90
v_add_f32 v75, v75, v91
v_add_f32 v76, v76, v92
v_add_f32 v77, v77, v93
v_add_f32 v78, v78, v94
v_add_f32 v79, v79, v95
v_add_f32 v80, v80, v96
v_add_f32 v81, v81, v97
v_add_f32 v82, v82, v98
v_add_f32 v83, v83, v99
v_add_f32 v84, v84, v100
v_add_f32 v85, v85, v101
v_add_f32 v86, v86, v102
v_add_f32 v87, v87, v103
Lfb_1002:
v_max3_f32 v129, v129, v72, v73
v_max3_f32 v129, v129, v74, v75
v_max3_f32 v129, v129, v76, v77
v_max3_f32 v129, v129, v78, v79
v_max3_f32 v129, v129, v80, v81
v_max3_f32 v129, v129, v82, v83
v_max3_f32 v129, v129, v84, v85
v_max3_f32 v129, v129, v86, v87
v_subrev_u32 v128, 1024, v128
s_add_u32 s87, s87, 1
s_cmp_le_u32 s87, s88
s_cbranch_scc1 Lfa_1001
v_mov_b32 v132, v129
s_nop 1
v_permlane32_swap_b32 v129, v132
v_max_f32 v129, v129, v132
v_lshlrev_b32 v130, 3, v27
v_sub_u32 v130, v26, v130
s_mov_b32 s87, 0
v_add_u32 v128, 8192, v25
v_mov_b32 v112, 0
v_mov_b32 v113, 0
v_mov_b32 v114, 0
v_mov_b32 v115, 0
v_mov_b32 v116, 0
v_mov_b32 v117, 0
v_mov_b32 v118, 0
v_mov_b32 v119, 0
v_mov_b32 v120, 0
v_mov_b32 v121, 0
v_mov_b32 v122, 0
v_mov_b32 v123, 0
v_mov_b32 v124, 0
v_mov_b32 v125, 0
v_mov_b32 v126, 0
v_mov_b32 v127, 0
Lfbb_1003:
ds_read_b64_tr_b16 v[56:57], v130 offset:0
ds_read_b64_tr_b16 v[58:59], v130 offset:256
ds_read_b64_tr_b16 v[60:61], v130 offset:512
ds_read_b64_tr_b16 v[62:63], v130 offset:768
ds_read_b128 v[48:51], v128
s_waitcnt lgkmcnt(0)
v_mfma_f32_32x32x16_bf16 v[72:87], v[48:51], v[44:47], 0
s_and_b32 s83, s87, 7
s_cmp_lg_u32 s83, 0
s_nop 15
s_cbranch_scc1 Lfb_1004
s_lshl_b32 s83, s87, 9
v_add_u32 v131, s83, v28
ds_read_b128 v[88:91], v131 offset:0
ds_read_b128 v[92:95], v131 offset:1024
ds_read_b128 v[96:99], v131 offset:2048
ds_read_b128 v[100:103], v131 offset:3072
s_waitcnt lgkmcnt(0)
v_add_f32 v72, v72, v88
v_add_f32 v73, v73, v89
v_add_f32 v74, v74, v90
v_add_f32 v75, v75, v91
v_add_f32 v76, v76, v92
v_add_f32 v77, v77, v93
v_add_f32 v78, v78, v94
v_add_f32 v79, v79, v95
v_add_f32 v80, v80, v96
v_add_f32 v81, v81, v97
v_add_f32 v82, v82, v98
v_add_f32 v83, v83, v99
v_add_f32 v84, v84, v100
v_add_f32 v85, v85, v101
v_add_f32 v86, v86, v102
v_add_f32 v87, v87, v103
Lfb_1004:
v_sub_f32 v72, v72, v129
v_sub_f32 v73, v73, v129
v_sub_f32 v74, v74, v129
v_sub_f32 v75, v75, v129
v_sub_f32 v76, v76, v129
v_sub_f32 v77, v77, v129
v_sub_f32 v78, v78, v129
v_sub_f32 v79, v79, v129
v_sub_f32 v80, v80, v129
v_sub_f32 v81, v81, v129
v_sub_f32 v82, v82, v129
v_sub_f32 v83, v83, v129
v_sub_f32 v84, v84, v129
v_sub_f32 v85, v85, v129
v_sub_f32 v86, v86, v129
v_sub_f32 v87, v87, v129
v_exp_f32 v72, v72
v_exp_f32 v73, v73
v_exp_f32 v74, v74
v_exp_f32 v75, v75
v_exp_f32 v76, v76
v_exp_f32 v77, v77
v_exp_f32 v78, v78
v_exp_f32 v79, v79
v_exp_f32 v80, v80
v_exp_f32 v81, v81
v_exp_f32 v82, v82
v_exp_f32 v83, v83
v_exp_f32 v84, v84
v_exp_f32 v85, v85
v_exp_f32 v86, v86
v_exp_f32 v87, v87
s_nop 0
v_cvt_pk_bf16_f32 v104, v72, v73
v_cvt_pk_bf16_f32 v105, v74, v75
v_cvt_pk_bf16_f32 v106, v76, v77
v_cvt_pk_bf16_f32 v107, v78, v79
v_cvt_pk_bf16_f32 v108, v80, v81
v_cvt_pk_bf16_f32 v109, v82, v83
v_cvt_pk_bf16_f32 v110, v84, v85
v_cvt_pk_bf16_f32 v111, v86, v87
s_nop 1
v_mfma_f32_32x32x16_bf16 v[112:127], v[56:59], v[104:107], v[112:127]
v_mfma_f32_32x32x16_bf16 v[112:127], v[60:63], v[108:111], v[112:127]
v_subrev_u32 v128, 1024, v128
v_add_u32 v130, v130, v27
s_add_u32 s87, s87, 1
s_cmp_le_u32 s87, s88
s_cbranch_scc1 Lfbb_1003
s_nop 15
s_branch L_attfin
L_late:
s_waitcnt vmcnt(0)
s_mov_b64 exec, 1
buffer_store_dwordx2 v[4:5], off, s[44:47], s81 offset:128 sc1
s_mov_b64 exec, -1
s_mov_b32 s95, s12
buffer_load_dwordx2 v[32:33], v21, s[44:47], 0 offen sc1
s_waitcnt vmcnt(0)
v_cmp_ne_u64 vcc, s[84:85], v[32:33]
s_cbranch_vccnz Lsp_2001
Lspe_2002:
s_add_u32 m0, s21, 65536
s_nop 0
buffer_load_dwordx4 v1, s[44:47], s95 offen sc1 lds
s_add_u32 m0, s21, 66560
s_add_u32 s95, s95, 1024
s_cmp_eq_u32 s95, s101
s_cselect_b32 s95, s100, s95
buffer_load_dwordx4 v1, s[44:47], s95 offen sc1 lds
s_add_u32 m0, s21, 67584
s_add_u32 s95, s95, 1024
s_cmp_eq_u32 s95, s101
s_cselect_b32 s95, s100, s95
buffer_load_dwordx4 v1, s[44:47], s95 offen sc1 lds
s_add_u32 m0, s21, 68608
s_add_u32 s95, s95, 1024
s_cmp_eq_u32 s95, s101
s_cselect_b32 s95, s100, s95
buffer_load_dwordx4 v1, s[44:47], s95 offen sc1 lds
s_waitcnt vmcnt(0)
s_branch L_late_ret
L_codeend:
s_endpgm
.section .rodata,"a"
.p2align 6
.amdhsa_kernel parallel_sum__sliding_block__mixer_channel_mlp__prompt_kernel
  .amdhsa_next_free_vgpr 256
  .amdhsa_next_free_sgpr 102
  .amdhsa_accum_offset 256
  .amdhsa_group_segment_fixed_size 0
  .amdhsa_kernarg_size 88
  .amdhsa_user_sgpr_count 2
  .amdhsa_user_sgpr_kernarg_segment_ptr 1
  .amdhsa_system_sgpr_workgroup_id_x 1
  .amdhsa_float_denorm_mode_32 3
.end_amdhsa_kernel
```
